```python
import torch

def _softmax(x, axis=-1):
    return torch.softmax(x, dim=axis)
def _gelu(x):
    return torch.nn.functional.gelu(x, approximate="tanh")
def _silu(x):
    return torch.nn.functional.silu(x)
def _sigmoid(x):
    return torch.sigmoid(x)
def _layernorm(x, axis=-1, eps=1e-5):
    m = x.mean(dim=axis, keepdim=True)
    v = x.var(dim=axis, keepdim=True, unbiased=False)
    return (x - m) / torch.sqrt(v + eps)
def _scatter_add(tgt, idx, src, axis=0):
    return tgt.clone().index_add_(axis, idx, src)
def _segment_sum(src, seg, n):
    out = torch.zeros((n,) + src.shape[1:], dtype=src.dtype)
    return out.index_add_(0, seg, src)
def _pad(x, pw):
    flat = tuple(v for pair in reversed(pw) for v in pair)
    return torch.nn.functional.pad(x, flat)

kernel_name = 'interleave_layers__sliding_block_cached__dense_activation_silu__decode'

def setup_inputs():

    _w = (lambda a: (lambda t: t.to(torch.bfloat16) if t.is_floating_point() else t)(torch.as_tensor(a)))
    def _A_setup():
        B, Sq, D = 8, 1, 1024
        Hq, Hkv, Sk, Dh = 32, 4, 4096, 128
        assert Hq % Hkv == 0, (Hq, Hkv)
        return {
            "x": _w((lambda *s: torch.randn(*s, dtype=torch.bfloat16) * 0.05)(B, Sq, D)),
            "k_cache": _w((lambda *s: torch.randn(*s, dtype=torch.bfloat16) * 0.8)(B, Hkv, Sk, Dh)),
            "v_cache": _w((lambda *s: torch.randn(*s, dtype=torch.bfloat16) * 1.6)(B, Hkv, Sk, Dh)),
            "wq": _w((lambda *s: torch.randn(*s, dtype=torch.bfloat16) * 0.8)(D, Hq * Dh) * (D ** -0.5)),
            "wo": _w((lambda *s: torch.randn(*s, dtype=torch.bfloat16) * 1.6)(Hq * Dh, D) * ((Hq * Dh) ** -0.5)),
        }
    _A_in = _A_setup()

    def _B_setup():
        B, S, D, F = 8, 1, 1024, 3584
        return {
            "x": _w((lambda *s: torch.randn(*s, dtype=torch.bfloat16) * 0.05)(B, S, D)),
            "w1": _w((lambda *s: torch.randn(*s, dtype=torch.bfloat16) * 1.6)(D, F) * (D ** -0.5)),
            "w2": _w((lambda *s: torch.randn(*s, dtype=torch.bfloat16) * 0.2)(F, D) * (F ** -0.5)),
        }
    _B_in = _B_setup()

    return {
        "A_x": _A_in["x"],
        "A_k_cache": _A_in["k_cache"],
        "A_v_cache": _A_in["v_cache"],
        "A_wq": _A_in["wq"],
        "A_wo": _A_in["wo"],
        "B_x": _B_in["x"],
        "B_w1": _B_in["w1"],
        "B_w2": _B_in["w2"],
    }

def reference(A_x, A_k_cache, A_v_cache, A_wq, A_wo, B_x, B_w1, B_w2):
    def _A_ref(x, k_cache, v_cache, wq, wo):
        B, Sq, D = x.shape
        Hq, Dh = 32, 128
        Hkv, Sk = k_cache.shape[1], k_cache.shape[2]
        W = min(4096, max(256, Sk // 4))
        rep = Hq // Hkv
        q = (lambda x, *d: x.permute(*d))((x @ wq).reshape(B, Sq, Hq, Dh), 0, 2, 1, 3)
        k = (lambda x, n, axis: torch.repeat_interleave(x, n, dim=axis))(k_cache[:, :, Sk - W:, :], rep, axis=1)
        v = (lambda x, n, axis: torch.repeat_interleave(x, n, dim=axis))(v_cache[:, :, Sk - W:, :], rep, axis=1)
        scores = torch.einsum("bhqd,bhkd->bhqk", q, k) * (Dh ** -0.5)
        p = _softmax(scores, axis=-1)
        o = torch.einsum("bhqk,bhkd->bhqd", p, v)
        return (lambda x, *d: x.permute(*d))(o, 0, 2, 1, 3).reshape(B, Sq, Hq * Dh) @ wo

    def _B_ref(x, w1, w2):
        h = torch.einsum("bsd,df->bsf", x, w1)
        h = _silu(h)
        out = torch.einsum("bsf,fd->bsd", h, w2)
        return out

    x = A_x
    x = x + _A_ref(_layernorm(x, axis=-1), A_k_cache, A_v_cache, A_wq, A_wo)
    x = x + _B_ref(_layernorm(x, axis=-1), B_w1, B_w2)
    x = x + _A_ref(_layernorm(x, axis=-1), A_k_cache, A_v_cache, A_wq, A_wo)
    x = x + _B_ref(_layernorm(x, axis=-1), B_w1, B_w2)
    return x
```

```asm
; @launch grid=(256,1,1) block=(512,1,1) lds=61440
.amdgcn_target "amdgcn-amd-amdhsa--gfx950"
.text
.globl interleave_layers__sliding_block_cached__dense_activation_silu__decode_kernel
.p2align 8
.type interleave_layers__sliding_block_cached__dense_activation_silu__decode_kernel,@function
interleave_layers__sliding_block_cached__dense_activation_silu__decode_kernel:
    s_cmp_ge_u32 s2, 256
    s_cbranch_scc1 L_end
    s_load_dwordx16 s[80:95], s[0:1], 0
    s_load_dwordx4 s[96:99], s[0:1], 64
    s_load_dwordx2 s[100:101], s[0:1], 80
    s_getpc_b64 s[4:5]
L_pc:
    v_lshlrev_b32 v2, 6, v0
    v_min_u32 v2, L_codeend-L_pc-4, v2
    v_mov_b32 v3, s5
    v_add_co_u32 v2, vcc, s4, v2
    v_addc_co_u32 v3, vcc, 0, v3, vcc
    global_load_dword v247, v[2:3], off
    v_lshrrev_b32 v1, 6, v0
    v_and_b32 v252, 63, v0
    s_and_b32 s49, s2, 7
    v_readfirstlane_b32 s3, v1
    s_lshr_b32 s50, s2, 3
    s_and_b32 s48, s3, 3
    v_lshlrev_b32 v255, 4, v252
    v_and_b32 v251, 15, v252
    v_lshrrev_b32 v250, 4, v252
    s_lshr_b32 s4, s50, 3
    s_and_b32 s5, s50, 7
    s_cmp_lt_u32 s3, 4
    s_cbranch_scc1 L_wq
    v_and_b32 v108, 7, v251
    v_lshrrev_b32 v109, 3, v251
    v_lshlrev_b32 v147, 11, v108
    v_lshl_add_u32 v147, v250, 3, v147
    s_mov_b32 s53, 0x0
    s_lshl_b32 s54, s49, 8
    s_add_u32 s53, s53, s54
    s_lshl_b32 s54, s48, 6
    s_add_u32 s53, s53, s54
    v_add_u32 v147, s53, v147
    s_waitcnt lgkmcnt(0)
    s_mov_b32 s36, s80
    s_and_b32 s37, s81, 0xffff
    s_mov_b32 s38, 0x4000
    s_mov_b32 s39, 0x20000
    buffer_load_dwordx2 v[116:117], v147, s[36:39], 0 offen
    buffer_load_dwordx2 v[118:119], v147, s[36:39], 0 offen offset:32
    v_mov_b32 v0, -1
    v_mov_b32 v1, -1
    v_mov_b32 v2, -1
    v_mov_b32 v3, -1
    s_mov_b32 s58, 0x218000
    s_lshl_b32 s54, s2, 11
    s_add_u32 s58, s58, s54
    s_mov_b32 s59, 0x0
    s_lshl_b32 s54, s4, 17
    s_add_u32 s59, s59, s54
    s_lshl_b32 s54, s49, 14
    s_add_u32 s59, s59, s54
    s_lshl_b32 s54, s5, 11
    s_add_u32 s59, s59, s54
    s_mov_b32 s60, 0x210000
    s_lshl_b32 s54, s4, 13
    s_add_u32 s60, s60, s54
    s_lshl_b32 s54, s49, 10
    s_add_u32 s60, s60, s54
    s_lshl_b32 s54, s5, 7
    s_add_u32 s60, s60, s54
    s_mov_b32 s64, 0x200000
    s_lshl_b32 s54, s2, 7
    s_add_u32 s64, s64, s54
    v_lshlrev_b32 v110, 4, v251
    s_mov_b32 s53, 0x298000
    s_lshl_b32 s54, s2, 8
    s_add_u32 s53, s53, s54
    v_add_u32 v111, s53, v110
    s_mov_b32 exec_lo, 0xff0000
    s_mov_b32 exec_hi, 0x0
    v_add_u32 v111, s64, v110
    s_mov_b32 exec_lo, 0x0
    s_mov_b32 exec_hi, 0xff
    v_add_u32 v111, s60, v110
    s_mov_b64 exec, -1
    s_cmp_lg_u32 s48, 1
    s_cbranch_scc1 L_common
    s_mov_b32 s8, s100
    s_and_b32 s9, s101, 0xffff
    s_mov_b32 s10, 0x800000
    s_mov_b32 s11, 0x20000
    buffer_store_dwordx4 v[0:3], v255, s[8:11], s58 offen offset:0 sc1
    buffer_store_dwordx4 v[0:3], v255, s[8:11], s58 offen offset:1024 sc1
    s_mov_b32 exec_lo, 0xffffff
    s_mov_b32 exec_hi, 0xff
    buffer_store_dwordx4 v[0:3], v111, s[8:11], 0 offen sc1
    s_mov_b64 exec, -1
    buffer_store_dwordx4 v[0:3], v255, s[8:11], s59 offen offset:0 sc1
    buffer_store_dwordx4 v[0:3], v255, s[8:11], s59 offen offset:1024 sc1
    s_branch L_common
L_wq:
    s_waitcnt lgkmcnt(0)
    s_mov_b32 s12, s86
    s_and_b32 s13, s87, 0xffff
    s_mov_b32 s14, 0x800000
    s_mov_b32 s15, 0x20000
    v_lshrrev_b32 v208, 2, v252
    v_mul_u32_u24 v208, 8192, v208
    v_and_b32 v209, 3, v252
    v_lshl_add_u32 v208, v209, 4, v208
    s_lshl_b32 s54, s48, 6
    v_add_u32 v208, s54, v208
    s_lshl_b32 s53, s49, 20
    s_lshl_b32 s54, s50, 8
    s_add_u32 s53, s53, s54
    buffer_load_dwordx4 v[0:3], v208, s[12:15], s53 offen
    s_add_u32 s53, s53, 131072
    buffer_load_dwordx4 v[4:7], v208, s[12:15], s53 offen
    s_add_u32 s53, s53, 131072
    buffer_load_dwordx4 v[8:11], v208, s[12:15], s53 offen
    s_add_u32 s53, s53, 131072
    buffer_load_dwordx4 v[12:15], v208, s[12:15], s53 offen
    s_add_u32 s53, s53, 131072
    buffer_load_dwordx4 v[16:19], v208, s[12:15], s53 offen
    s_add_u32 s53, s53, 131072
    buffer_load_dwordx4 v[20:23], v208, s[12:15], s53 offen
    s_add_u32 s53, s53, 131072
    buffer_load_dwordx4 v[24:27], v208, s[12:15], s53 offen
    s_add_u32 s53, s53, 131072
    buffer_load_dwordx4 v[28:31], v208, s[12:15], s53 offen
L_common:
    s_mov_b32 s1, 0x2d0000
    s_load_dword s0, s[100:101], s1
    s_lshl_b32 s55, s4, 3
    s_add_u32 s55, s55, s49
    s_add_u32 s53, s50, 1
    s_and_b32 s53, s53, 3
    s_and_b32 s54, s50, 28
    s_add_u32 s6, s53, s54
    s_cmp_lt_u32 s6, 28
    s_cselect_b32 s56, 1, 0
    s_lshl_b32 s6, s6, 3
    s_add_u32 s6, s6, s49
    s_xor_b32 s53, s53, 2
    s_add_u32 s54, s54, 4
    s_and_b32 s54, s54, 28
    s_add_u32 s53, s53, s54
    s_mul_i32 s7, s49, 28
    s_add_u32 s7, s7, s53
    s_lshl_b32 s54, s53, 3
    s_add_u32 s54, s54, s49
    s_cmp_lt_u32 s53, 28
    s_cselect_b32 s57, 1, 0
    s_cselect_b32 s7, s7, s54
    s_mov_b32 s51, 0
    s_mov_b32 s52, 40000
    s_mov_b32 s8, s100
    s_and_b32 s9, s101, 0xffff
    s_mov_b32 s10, 0x800000
    s_mov_b32 s11, 0x20000
    s_mov_b32 s36, s80
    s_and_b32 s37, s81, 0xffff
    s_mov_b32 s38, 0x4000
    s_mov_b32 s39, 0x20000
    s_mov_b32 s40, s96
    s_and_b32 s41, s97, 0xffff
    s_mov_b32 s42, 0x4000
    s_mov_b32 s43, 0x20000
    s_cmp_ge_u32 s3, 4
    s_cbranch_scc1 L_common2
    s_mov_b32 s16, s82
    s_and_b32 s17, s83, 0xffff
    s_mov_b32 s18, 0x2000000
    s_mov_b32 s19, 0x20000
    s_mov_b32 s20, s84
    s_and_b32 s21, s85, 0xffff
    s_mov_b32 s22, 0x2000000
    s_mov_b32 s23, 0x20000
    s_mov_b32 s24, s88
    s_and_b32 s25, s89, 0xffff
    s_mov_b32 s26, 0x800000
    s_mov_b32 s27, 0x20000
    s_mov_b32 s28, s92
    s_and_b32 s29, s93, 0xffff
    s_mov_b32 s30, 0x700000
    s_mov_b32 s31, 0x20000
    s_mov_b32 s32, s94
    s_and_b32 s33, s95, 0xffff
    s_mov_b32 s34, 0x700000
    s_mov_b32 s35, 0x20000
L_common2:
    s_mov_b32 s58, 0x218000
    s_lshl_b32 s54, s2, 11
    s_add_u32 s58, s58, s54
    s_mov_b32 s59, 0x0
    s_lshl_b32 s54, s4, 17
    s_add_u32 s59, s59, s54
    s_lshl_b32 s54, s49, 14
    s_add_u32 s59, s59, s54
    s_lshl_b32 s54, s5, 11
    s_add_u32 s59, s59, s54
    s_mov_b32 s60, 0x210000
    s_lshl_b32 s54, s4, 13
    s_add_u32 s60, s60, s54
    s_lshl_b32 s54, s49, 10
    s_add_u32 s60, s60, s54
    s_lshl_b32 s54, s5, 7
    s_add_u32 s60, s60, s54
    s_mov_b32 s61, 0x80000
    s_lshl_b32 s54, s5, 16
    s_add_u32 s61, s61, s54
    s_lshl_b32 s54, s55, 11
    s_add_u32 s61, s61, s54
    s_xor_b32 s61, s61, 0x20000
    s_mov_b32 s62, 0x100000
    s_lshl_b32 s54, s6, 11
    s_add_u32 s62, s62, s54
    s_lshr_b32 s76, s7, 3
    s_and_b32 s77, s7, 7
    s_mov_b32 s63, 0x180000
    s_lshl_b32 s54, s77, 16
    s_add_u32 s63, s63, s54
    s_lshl_b32 s54, s76, 11
    s_add_u32 s63, s63, s54
    s_mov_b32 s64, 0x200000
    s_lshl_b32 s54, s2, 7
    s_add_u32 s64, s64, s54
    s_mov_b32 s65, 0x208000
    s_lshl_b32 s54, s6, 7
    s_add_u32 s65, s65, s54
    s_cmp_lt_u32 s3, 4
    s_cbranch_scc1 L_wt
    s_cmp_eq_u32 s48, 1
    s_cbranch_scc1 L_nsm
L_cl2:
    s_mov_b32 s53, s59
    s_cmp_eq_u32 s48, 0
    s_cselect_b32 s53, s61, s53
    s_cmp_eq_u32 s48, 2
    s_cselect_b32 s53, s62, s53
    s_cmp_eq_u32 s48, 3
    s_cselect_b32 s53, s63, s53
    buffer_store_dwordx4 v[0:3], v255, s[8:11], s53 offen offset:0 sc1
    buffer_store_dwordx4 v[0:3], v255, s[8:11], s53 offen offset:1024 sc1
    s_bitcmp1_b32 s48, 0
    s_cbranch_scc1 L_nsm
    s_mov_b32 s53, 0x2a8000
    s_lshl_b32 s54, s6, 8
    s_add_u32 s53, s53, s54
    s_cmp_eq_u32 s48, 0
    s_cselect_b32 s53, s65, s53
    s_cselect_b32 exec_lo, 0xff, -1
    s_and_b32 exec_lo, exec_lo, 0xffff
    s_mov_b32 exec_hi, 0
    buffer_store_dwordx4 v[0:3], v255, s[8:11], s53 offen sc1
L_nsm:
    s_mov_b64 exec, -1
    v_lshlrev_b32 v146, 3, v108
    s_mov_b32 exec_lo, 0xffffffff
    s_mov_b32 exec_hi, 0x0
    v_add_u32 v146, 4, v146
    s_mov_b64 exec, -1
    s_mov_b32 s66, 0xffe80000
    s_lshl_b32 s54, s49, 16
    s_add_u32 s66, s66, s54
    s_mov_b32 s67, 0x80000
    s_lshl_b32 s54, s49, 16
    s_add_u32 s67, s67, s54
    s_mov_b32 s68, 0x218000
    s_lshl_b32 s54, s4, 17
    s_add_u32 s68, s68, s54
    s_lshl_b32 s54, s49, 6
    s_add_u32 s68, s68, s54
    s_mov_b32 s69, 0x298000
    s_lshl_b32 s54, s4, 14
    s_add_u32 s69, s69, s54
    s_mov_b32 s70, 0x200000
    s_lshl_b32 s54, s50, 10
    s_add_u32 s70, s70, s54
    s_lshl_b32 s54, s49, 3
    s_add_u32 s70, s70, s54
    s_mov_b32 s71, 0x0
    s_lshl_b32 s54, s4, 17
    s_add_u32 s71, s71, s54
    s_lshl_b32 s54, s49, 6
    s_add_u32 s71, s71, s54
    s_mov_b32 s72, 0x210000
    s_lshl_b32 s54, s4, 13
    s_add_u32 s72, s72, s54
    s_lshl_b32 s54, s49, 3
    s_add_u32 s72, s72, s54
    s_lshr_b32 s76, s7, 3
    s_mov_b32 s73, 0x100000
    s_lshl_b32 s54, s76, 14
    s_add_u32 s73, s73, s54
    s_mov_b32 s74, 0x2a8000
    s_lshl_b32 s54, s76, 11
    s_add_u32 s74, s74, s54
    s_mov_b32 s75, 0x208000
    s_lshl_b32 s54, s76, 10
    s_add_u32 s75, s75, s54
    v_and_b32 v111, 2, v250
    v_add_u32 v111, v111, v109
    v_and_b32 v112, 1, v250
    s_lshl_b32 s53, s48, 9
    v_lshl_add_u32 v140, v111, 11, s53
    v_lshl_add_u32 v140, v112, 7, v140
    v_lshl_add_u32 v140, v108, 4, v140
    s_lshl_b32 s53, s48, 6
    v_lshl_add_u32 v141, v111, 8, s53
    v_lshl_add_u32 v141, v112, 4, v141
    v_lshl_add_u32 v142, v250, 1, v109
    v_lshlrev_b32 v142, 7, v142
    v_lshl_add_u32 v149, v108, 3, v142
    s_lshl_b32 s53, s48, 12
    v_lshl_add_u32 v143, v250, 9, s53
    v_lshl_add_u32 v143, v251, 4, v143
    s_lshl_b32 s53, s48, 11
    v_lshl_add_u32 v144, v109, 10, s53
    v_lshl_add_u32 v144, v250, 8, v144
    s_lshl_b32 s53, s48, 15
    v_lshl_add_u32 v151, v250, 12, s53
    v_lshrrev_b32 v152, 2, v251
    v_lshl_add_u32 v151, v152, 9, v151
    v_and_b32 v152, 3, v251
    v_lshl_add_u32 v151, v152, 4, v151
    v_add_u32 v152, 0x4000, v151
    s_lshl_b32 s53, s48, 5
    v_lshl_add_u32 v145, v250, 3, s53
    v_lshl_add_u32 v145, v251, 8, v145
    s_lshl_b32 s53, s48, 10
    v_add_u32 v150, s53, v255
    s_mov_b32 s76, 0x0
    s_lshl_b32 s54, s4, 13
    s_add_u32 s76, s76, s54
    s_lshl_b32 s54, s48, 11
    s_add_u32 s76, s76, s54
    v_lshl_add_u32 v191, v251, 7, s76
    s_lshl_b32 s76, s50, 10
    s_mov_b32 exec_lo, 0xff0000
    s_mov_b32 exec_hi, 0x0
    v_lshl_add_u32 v191, v251, 7, s76
    s_mov_b64 exec, -1
    v_mov_b32 v148, 1.0
    s_mov_b32 s76, 0x4
    s_lshl_b32 s54, s48, 13
    s_add_u32 s76, s76, s54
    v_lshl_add_u32 v188, v252, 7, s76
    v_and_b32 v113, 1, v251
    v_lshlrev_b32 v113, 4, v113
    v_mov_b32 v114, 0xffff
    v_lshlrev_b32 v114, v113, v114
    v_lshrrev_b32 v113, 1, v251
    v_cmp_eq_u32 vcc, 0, v113
    s_nop 1
    v_cndmask_b32 v72, 0, v114, vcc
    v_cmp_eq_u32 vcc, 1, v113
    s_nop 1
    v_cndmask_b32 v73, 0, v114, vcc
    v_cmp_eq_u32 vcc, 2, v113
    s_nop 1
    v_cndmask_b32 v74, 0, v114, vcc
    v_cmp_eq_u32 vcc, 3, v113
    s_nop 1
    v_cndmask_b32 v75, 0, v114, vcc
    v_cmp_eq_u32 vcc, 4, v113
    s_nop 1
    v_cndmask_b32 v76, 0, v114, vcc
    v_cmp_eq_u32 vcc, 5, v113
    s_nop 1
    v_cndmask_b32 v77, 0, v114, vcc
    v_cmp_eq_u32 vcc, 6, v113
    s_nop 1
    v_cndmask_b32 v78, 0, v114, vcc
    v_cmp_eq_u32 vcc, 7, v113
    s_nop 1
    v_cndmask_b32 v79, 0, v114, vcc
    v_and_b32 v80, 0x3f803f80, v72
    v_and_b32 v81, 0x3f803f80, v73
    v_and_b32 v82, 0x3f803f80, v74
    v_and_b32 v83, 0x3f803f80, v75
    v_and_b32 v84, 0x3f803f80, v76
    v_and_b32 v85, 0x3f803f80, v77
    v_and_b32 v86, 0x3f803f80, v78
    v_and_b32 v87, 0x3f803f80, v79
    v_cmp_eq_u32 vcc, 0, v112
    s_nop 1
    v_cndmask_b32 v88, v84, v80, vcc
    v_cndmask_b32 v89, v85, v81, vcc
    v_cndmask_b32 v90, v86, v82, vcc
    v_cndmask_b32 v91, v87, v83, vcc
    s_waitcnt vmcnt(5)
    s_cmp_eq_u32 s48, 1
    s_cbranch_scc1 L_x0p
    s_waitcnt vmcnt(3)
    s_cmp_lg_u32 s48, 3
    s_cbranch_scc1 L_x0p
    s_waitcnt vmcnt(2)
L_x0p:
    s_waitcnt lgkmcnt(0)
    s_add_u32 s0, s0, 1
    v_mov_b32 v248, s0
L_x0:
    v_lshlrev_b32 v64, 16, v116
    v_and_b32 v65, 0xffff0000, v116
    v_lshlrev_b32 v66, 16, v117
    v_and_b32 v67, 0xffff0000, v117
    v_lshlrev_b32 v68, 16, v118
    v_and_b32 v69, 0xffff0000, v118
    v_lshlrev_b32 v70, 16, v119
    v_and_b32 v71, 0xffff0000, v119
    s_mov_b32 exec_lo, 0xff00ff00
    s_mov_b32 exec_hi, 0xff00ff00
    v_mov_b32 v116, 0x3f803f80
    v_mov_b32 v117, 0x3f803f80
    v_mov_b32 v118, 0x3f803f80
    v_mov_b32 v119, 0x3f803f80
    s_mov_b64 exec, -1
    ds_write_b128 v150, v[116:119] offset:0
    s_waitcnt lgkmcnt(0)
    s_cmp_lg_u32 s51, 0
    s_cbranch_scc1 L_skip_fs
    s_cmp_lg_u32 s48, 1
    s_cbranch_scc1 L_skip_fs
    s_waitcnt vmcnt(0)
    s_mov_b32 s53, 0x2c0000
    s_lshl_b32 s54, s2, 7
    s_add_u32 s53, s53, s54
    s_mov_b32 exec_lo, 0x1
    s_mov_b32 exec_hi, 0x0
    buffer_store_dword v248, off, s[8:11], s53 sc1
    s_mov_b64 exec, -1
L_skip_fs:
    s_barrier
    s_cmp_lg_u32 s48, 0
    s_cbranch_scc1 L_ng0
    ds_read_b128 v[0:3], v255 offset:0
    ds_read_b128 v[4:7], v255 offset:1024
    ds_read_b128 v[8:11], v255 offset:2048
    ds_read_b128 v[12:15], v255 offset:3072
    s_waitcnt lgkmcnt(0)
    v_mfma_f32_16x16x32_bf16 v[92:95], v[0:3], v[0:3], 0
    v_mfma_f32_16x16x32_bf16 v[92:95], v[4:7], v[4:7], v[92:95]
    v_mfma_f32_16x16x32_bf16 v[92:95], v[8:11], v[8:11], v[92:95]
    v_mfma_f32_16x16x32_bf16 v[92:95], v[12:15], v[12:15], v[92:95]
    s_nop 7
    s_mov_b32 exec_lo, 0x200002
    s_mov_b32 exec_hi, 0x0
    v_mov_b32 v92, v93
    s_mov_b32 exec_lo, 0x400004
    s_mov_b32 exec_hi, 0x0
    v_mov_b32 v92, v94
    s_mov_b32 exec_lo, 0x800008
    s_mov_b32 exec_hi, 0x0
    v_mov_b32 v92, v95
    s_mov_b32 exec_lo, 0xf0000f
    s_mov_b32 exec_hi, 0xff
    buffer_store_dword v92, v146, s[8:11], s64 offen sc1
    s_mov_b64 exec, -1
L_ng0:
    s_barrier
    s_cmp_lg_u32 s51, 0
    s_cbranch_scc1 L_skip_flag
    s_mov_b32 s53, 0x2c0000
    s_mov_b32 exec_lo, 0xffffff
    s_mov_b32 exec_hi, 0x0
L_flg:
    buffer_load_dword v192, v191, s[8:11], s53 offen sc1
L_fcg:
    s_waitcnt vmcnt(0)
    v_cmp_ne_u32 s[78:79], v248, v192
    s_cmp_eq_u64 s[78:79], 0
    s_cbranch_scc1 L_fdg
    s_sleep 2
    s_sub_u32 s52, s52, 1
    s_cmp_gt_i32 s52, 0
    s_cbranch_scc1 L_flg
L_fdg:
    s_mov_b64 exec, -1
L_skip_flag:
    s_cmp_lg_u32 s51, 0
    s_cbranch_scc1 L_skip_cq0False
    buffer_load_dwordx4 v[16:19], v143, s[8:11], s69 offen offset:0 sc1
    buffer_load_dwordx4 v[20:23], v143, s[8:11], s69 offen offset:256 sc1
    buffer_load_dwordx4 v[24:27], v143, s[8:11], s69 offen offset:2048 sc1
    buffer_load_dwordx4 v[28:31], v143, s[8:11], s69 offen offset:2304 sc1
L_skip_cq0False:
    buffer_load_dwordx2 v[108:109], v142, s[8:11], s70 offen sc1
    buffer_load_dwordx4 v[0:3], v151, s[8:11], s68 offen offset:0 sc1
    buffer_load_dwordx4 v[4:7], v151, s[8:11], s68 offen offset:2048 sc1
    buffer_load_dwordx4 v[8:11], v152, s[8:11], s68 offen offset:0 sc1
    buffer_load_dwordx4 v[12:15], v152, s[8:11], s68 offen offset:2048 sc1
    s_cmp_lg_u32 s51, 0
    s_cbranch_scc1 L_skip_y
    s_barrier
L_skip_y:
L_pm_q:
    s_waitcnt vmcnt(4)
    v_mfma_f32_16x16x4_f32 v[100:103], v148, v108, 0
    v_mfma_f32_16x16x4_f32 v[104:107], v148, v109, 0
    s_cmp_lg_u32 s51, 0
    s_cbranch_scc1 L_skip_cq
    v_mfma_f32_16x16x32_bf16 v[176:179], v[80:83], v[16:19], 0
    v_mfma_f32_16x16x32_bf16 v[176:179], v[80:83], v[20:23], v[176:179]
    v_mfma_f32_16x16x32_bf16 v[176:179], v[84:87], v[24:27], v[176:179]
    v_mfma_f32_16x16x32_bf16 v[176:179], v[84:87], v[28:31], v[176:179]
L_skip_cq:
    s_nop 7
    v_add_f32_dpp v100, v100, v100 row_ror:8 row_mask:0xf bank_mask:0xf
    v_add_f32_dpp v104, v104, v104 row_ror:8 row_mask:0xf bank_mask:0xf
    s_mov_b32 s53, 0x3a800000
    v_mul_f32 v100, s53, v100
    v_mul_f32 v104, s53, v104
    v_fma_f32 v104, -v100, v100, v104
    v_max_f32 v104, 0, v104
    v_add_f32 v104, 0x3727c5ac, v104
    v_rsq_f32 v104, v104
    v_add_f32 v110, v105, v101
    v_mul_f32 v92, -v100, v176
    v_mul_f32 v93, -v100, v177
    v_mul_f32 v94, -v100, v178
    v_mul_f32 v95, -v100, v179
    s_nop 0
    s_waitcnt vmcnt(3)
    v_mfma_f32_16x16x32_bf16 v[92:95], v[80:83], v[0:3], v[92:95]
    s_waitcnt vmcnt(2)
    v_mfma_f32_16x16x32_bf16 v[92:95], v[80:83], v[4:7], v[92:95]
    s_waitcnt vmcnt(1)
    v_mfma_f32_16x16x32_bf16 v[92:95], v[84:87], v[8:11], v[92:95]
    s_waitcnt vmcnt(0)
    v_mfma_f32_16x16x32_bf16 v[92:95], v[84:87], v[12:15], v[92:95]
    s_nop 7
    v_mul_f32 v92, v104, v92
    v_mul_f32 v93, v104, v93
    v_mul_f32 v94, v104, v94
    v_mul_f32 v95, v104, v95
    v_cmp_u_f32 s[78:79], v92, v110
    s_cmp_lg_u64 s[78:79], 0
    s_cbranch_scc1 L_rt_q
L_pd_q:
    v_cvt_pk_bf16_f32 v116, v92, v93
    v_cvt_pk_bf16_f32 v117, v94, v95
    ds_write_b64 v145, v[116:117] offset:4096
    s_waitcnt lgkmcnt(0)
    s_barrier
    s_cmp_lg_u32 s51, 0
    s_cbranch_scc1 L_skip_c1
    s_cmp_lg_u32 s48, 1
    s_cbranch_scc1 L_skip_c1
    s_mov_b32 s53, 0x2c0004
    s_lshl_b32 s54, s2, 7
    s_add_u32 s53, s53, s54
    s_mov_b32 exec_lo, 0x1
    s_mov_b32 exec_hi, 0x0
    buffer_store_dword v248, off, s[8:11], s53 sc1
    s_mov_b64 exec, -1
L_skip_c1:
    s_barrier
    s_barrier
    s_cmp_lg_u32 s51, 0
    s_cbranch_scc1 L_skip_c3False
    s_mov_b32 s53, 0x2c0000
    buffer_load_dword v189, v188, s[8:11], s53 offen sc1
L_skip_c3False:
    buffer_load_dwordx2 v[108:109], v144, s[8:11], s72 offen offset:0 sc1
    buffer_load_dwordx2 v[110:111], v144, s[8:11], s72 offen offset:128 sc1
    buffer_load_dwordx4 v[0:3], v151, s[8:11], s71 offen offset:0 sc1
    buffer_load_dwordx4 v[4:7], v151, s[8:11], s71 offen offset:2048 sc1
    buffer_load_dwordx4 v[8:11], v152, s[8:11], s71 offen offset:0 sc1
    buffer_load_dwordx4 v[12:15], v152, s[8:11], s71 offen offset:2048 sc1
L_pm_a:
    s_waitcnt vmcnt(4)
    v_max_f32 v112, v108, v110
    v_mov_b32 v113, v112
    s_nop 1
    v_permlane16_swap_b32 v112, v113
    v_max_f32 v112, v112, v113
    v_mov_b32 v113, v112
    s_nop 1
    v_permlane32_swap_b32 v112, v113
    v_max_f32 v112, v112, v113
    v_sub_f32 v108, v108, v112
    v_sub_f32 v110, v110, v112
    v_exp_f32 v108, v108
    v_exp_f32 v110, v110
    s_nop 0
    v_cvt_pk_bf16_f32 v108, v108, v108
    v_cvt_pk_bf16_f32 v110, v110, v110
    v_and_b32 v160, v72, v108
    v_and_b32 v161, v73, v108
    v_and_b32 v162, v74, v108
    v_and_b32 v163, v75, v108
    v_and_b32 v164, v72, v110
    v_and_b32 v165, v73, v110
    v_and_b32 v166, v74, v110
    v_and_b32 v167, v75, v110
    v_and_b32 v168, v76, v108
    v_and_b32 v169, v77, v108
    v_and_b32 v170, v78, v108
    v_and_b32 v171, v79, v108
    v_and_b32 v172, v76, v110
    v_and_b32 v173, v77, v110
    v_and_b32 v174, v78, v110
    v_and_b32 v175, v79, v110
    v_and_b32 v108, 0xffff0000, v108
    v_and_b32 v110, 0xffff0000, v110
    s_waitcnt vmcnt(3)
    v_mfma_f32_16x16x32_bf16 v[92:95], v[160:163], v[0:3], 0
    s_waitcnt vmcnt(2)
    v_mfma_f32_16x16x32_bf16 v[92:95], v[164:167], v[4:7], v[92:95]
    s_waitcnt vmcnt(1)
    v_mfma_f32_16x16x32_bf16 v[92:95], v[168:171], v[8:11], v[92:95]
    s_waitcnt vmcnt(0)
    v_mfma_f32_16x16x32_bf16 v[92:95], v[172:175], v[12:15], v[92:95]
    v_mul_f32 v112, v108, v109
    v_fmac_f32 v112, v110, v111
    v_mov_b32 v113, v112
    s_nop 1
    v_permlane16_swap_b32 v112, v113
    v_add_f32 v112, v112, v113
    v_mov_b32 v113, v112
    s_nop 1
    v_permlane32_swap_b32 v112, v113
    v_add_f32 v112, v112, v113
    v_rcp_f32 v112, v112
    s_nop 0
    v_readlane_b32 s76, v112, 0
    v_readlane_b32 s77, v112, 8
    s_nop 1
    v_mov_b32 v112, s77
    s_mov_b32 exec_lo, 0xffffffff
    s_mov_b32 exec_hi, 0x0
    v_mov_b32 v112, s76
    s_mov_b64 exec, -1
    v_mul_f32 v92, v112, v92
    v_mul_f32 v93, v112, v93
    v_mul_f32 v94, v112, v94
    v_mul_f32 v95, v112, v95
    v_cmp_u_f32 s[78:79], v92, v93
    s_cmp_lg_u64 s[78:79], 0
    s_cbranch_scc1 L_rt_a
L_pd_a:
    v_cvt_pk_bf16_f32 v116, v92, v93
    v_cvt_pk_bf16_f32 v117, v94, v95
    ds_write_b64 v145, v[116:117] offset:8192
    s_waitcnt lgkmcnt(0)
    s_barrier
    s_cmp_lg_u32 s51, 0
    s_cbranch_scc1 L_skip_c2
    s_mov_b32 s53, 0x2c0000
    s_mov_b32 exec_lo, 0xffffffff
    s_mov_b32 exec_hi, 0xffffffff
    s_branch L_fca
L_fla:
    buffer_load_dword v189, v188, s[8:11], s53 offen sc1
L_fca:
    s_waitcnt vmcnt(0)
    v_cmp_ne_u32 s[78:79], v248, v189
    s_cmp_eq_u64 s[78:79], 0
    s_cbranch_scc1 L_fda
    s_sleep 2
    s_sub_u32 s52, s52, 1
    s_cmp_gt_i32 s52, 0
    s_cbranch_scc1 L_fla
L_fda:
    s_mov_b64 exec, -1
L_skip_c2:
    s_barrier
    s_add_u32 s53, s2, s48
    s_add_u32 s53, s53, s51
    s_cmp_lg_u32 s53, 0
    s_cbranch_scc1 L_nep
    s_mov_b32 s53, 0x2d0000
    s_mov_b32 exec_lo, 0x1
    s_mov_b32 exec_hi, 0x0
    buffer_store_dword v248, off, s[8:11], s53 sc1
    s_mov_b64 exec, -1
L_nep:
    s_mov_b32 s53, s67
    buffer_load_dwordx4 v[0:3], v140, s[8:11], s53 offen offset:0 sc1
    buffer_load_dwordx4 v[4:7], v140, s[8:11], s53 offen offset:256 sc1
    s_add_u32 s53, s53, 8192
    buffer_load_dwordx4 v[8:11], v140, s[8:11], s53 offen offset:0 sc1
    buffer_load_dwordx4 v[12:15], v140, s[8:11], s53 offen offset:256 sc1
    s_add_u32 s53, s53, 8192
    buffer_load_dwordx4 v[16:19], v140, s[8:11], s53 offen offset:0 sc1
    buffer_load_dwordx4 v[20:23], v140, s[8:11], s53 offen offset:256 sc1
    s_add_u32 s53, s53, 8192
    buffer_load_dwordx4 v[24:27], v140, s[8:11], s53 offen offset:0 sc1
    buffer_load_dwordx4 v[28:31], v140, s[8:11], s53 offen offset:256 sc1
    s_add_u32 s53, s53, 8192
    buffer_load_dwordx4 v[32:35], v140, s[8:11], s53 offen offset:0 sc1
    buffer_load_dwordx4 v[36:39], v140, s[8:11], s53 offen offset:256 sc1
    s_add_u32 s53, s53, 8192
    buffer_load_dwordx4 v[40:43], v140, s[8:11], s53 offen offset:0 sc1
    buffer_load_dwordx4 v[44:47], v140, s[8:11], s53 offen offset:256 sc1
    s_add_u32 s53, s53, 8192
    buffer_load_dwordx4 v[48:51], v140, s[8:11], s53 offen offset:0 sc1
    buffer_load_dwordx4 v[52:55], v140, s[8:11], s53 offen offset:256 sc1
    s_add_u32 s53, s53, 8192
    buffer_load_dwordx4 v[56:59], v140, s[8:11], s53 offen offset:0 sc1
    buffer_load_dwordx4 v[60:63], v140, s[8:11], s53 offen offset:256 sc1
L_pm_o:
    s_waitcnt vmcnt(15)
    v_mfma_f32_16x16x32_bf16 v[92:95], v[88:91], v[0:3], 0
    s_waitcnt vmcnt(14)
    v_mfma_f32_16x16x32_bf16 v[96:99], v[88:91], v[4:7], 0
    s_waitcnt vmcnt(13)
    v_mfma_f32_16x16x32_bf16 v[92:95], v[88:91], v[8:11], v[92:95]
    s_waitcnt vmcnt(12)
    v_mfma_f32_16x16x32_bf16 v[96:99], v[88:91], v[12:15], v[96:99]
    s_waitcnt vmcnt(11)
    v_mfma_f32_16x16x32_bf16 v[92:95], v[88:91], v[16:19], v[92:95]
    s_waitcnt vmcnt(10)
    v_mfma_f32_16x16x32_bf16 v[96:99], v[88:91], v[20:23], v[96:99]
    s_waitcnt vmcnt(9)
    v_mfma_f32_16x16x32_bf16 v[92:95], v[88:91], v[24:27], v[92:95]
    s_waitcnt vmcnt(8)
    v_mfma_f32_16x16x32_bf16 v[96:99], v[88:91], v[28:31], v[96:99]
    s_waitcnt vmcnt(7)
    v_mfma_f32_16x16x32_bf16 v[92:95], v[88:91], v[32:35], v[92:95]
    s_waitcnt vmcnt(6)
    v_mfma_f32_16x16x32_bf16 v[96:99], v[88:91], v[36:39], v[96:99]
    s_waitcnt vmcnt(5)
    v_mfma_f32_16x16x32_bf16 v[92:95], v[88:91], v[40:43], v[92:95]
    s_waitcnt vmcnt(4)
    v_mfma_f32_16x16x32_bf16 v[96:99], v[88:91], v[44:47], v[96:99]
    s_waitcnt vmcnt(3)
    v_mfma_f32_16x16x32_bf16 v[92:95], v[88:91], v[48:51], v[92:95]
    s_waitcnt vmcnt(2)
    v_mfma_f32_16x16x32_bf16 v[96:99], v[88:91], v[52:55], v[96:99]
    s_waitcnt vmcnt(1)
    v_mfma_f32_16x16x32_bf16 v[92:95], v[88:91], v[56:59], v[92:95]
    s_waitcnt vmcnt(0)
    v_mfma_f32_16x16x32_bf16 v[96:99], v[88:91], v[60:63], v[96:99]
    s_nop 7
    v_cmp_u_f32 s[78:79], v92, v96
    s_cmp_lg_u64 s[78:79], 0
    s_cbranch_scc1 L_rt_o
L_pd_o:
    v_add_f32_dpp v92, v92, v92 row_ror:8 row_mask:0xf bank_mask:0xf
    v_add_f32_dpp v93, v93, v93 row_ror:8 row_mask:0xf bank_mask:0xf
    v_add_f32_dpp v94, v94, v94 row_ror:8 row_mask:0xf bank_mask:0xf
    v_add_f32_dpp v95, v95, v95 row_ror:8 row_mask:0xf bank_mask:0xf
    v_add_f32_dpp v96, v96, v96 row_ror:8 row_mask:0xf bank_mask:0xf
    v_add_f32_dpp v97, v97, v97 row_ror:8 row_mask:0xf bank_mask:0xf
    v_add_f32_dpp v98, v98, v98 row_ror:8 row_mask:0xf bank_mask:0xf
    v_add_f32_dpp v99, v99, v99 row_ror:8 row_mask:0xf bank_mask:0xf
    v_add_f32 v92, v92, v64
    v_add_f32 v93, v93, v65
    v_add_f32 v94, v94, v66
    v_add_f32 v95, v95, v67
    v_add_f32 v96, v96, v68
    v_add_f32 v97, v97, v69
    v_add_f32 v98, v98, v70
    v_add_f32 v99, v99, v71
    v_cvt_pk_bf16_f32 v116, v92, v93
    v_cvt_pk_bf16_f32 v117, v94, v95
    v_cvt_pk_bf16_f32 v118, v96, v97
    v_cvt_pk_bf16_f32 v119, v98, v99
    v_lshlrev_b32 v64, 16, v116
    v_and_b32 v65, 0xffff0000, v116
    v_lshlrev_b32 v66, 16, v117
    v_and_b32 v67, 0xffff0000, v117
    v_lshlrev_b32 v68, 16, v118
    v_and_b32 v69, 0xffff0000, v118
    v_lshlrev_b32 v70, 16, v119
    v_and_b32 v71, 0xffff0000, v119
    s_mov_b32 exec_lo, 0xff00ff00
    s_mov_b32 exec_hi, 0xff00ff00
    v_mov_b32 v116, 0x3f803f80
    v_mov_b32 v117, 0x3f803f80
    v_mov_b32 v118, 0x3f803f80
    v_mov_b32 v119, 0x3f803f80
    s_mov_b64 exec, -1
    ds_write_b128 v150, v[116:119] offset:12288
    s_waitcnt lgkmcnt(0)
    s_barrier
    s_cmp_lg_u32 s48, 0
    s_cbranch_scc1 L_ng1
    s_cmp_eq_u32 s56, 0
    s_cbranch_scc1 L_ng1
    ds_read_b128 v[0:3], v255 offset:12288
    ds_read_b128 v[4:7], v255 offset:13312
    ds_read_b128 v[8:11], v255 offset:14336
    ds_read_b128 v[12:15], v255 offset:15360
    s_waitcnt lgkmcnt(0)
    v_mfma_f32_16x16x32_bf16 v[92:95], v[0:3], v[0:3], 0
    v_mfma_f32_16x16x32_bf16 v[92:95], v[4:7], v[4:7], v[92:95]
    v_mfma_f32_16x16x32_bf16 v[92:95], v[8:11], v[8:11], v[92:95]
    v_mfma_f32_16x16x32_bf16 v[92:95], v[12:15], v[12:15], v[92:95]
    s_nop 7
    s_mov_b32 exec_lo, 0x200002
    s_mov_b32 exec_hi, 0x0
    v_mov_b32 v92, v93
    s_mov_b32 exec_lo, 0x400004
    s_mov_b32 exec_hi, 0x0
    v_mov_b32 v92, v94
    s_mov_b32 exec_lo, 0x800008
    s_mov_b32 exec_hi, 0x0
    v_mov_b32 v92, v95
    s_mov_b32 exec_lo, 0xf0000f
    s_mov_b32 exec_hi, 0xff
    buffer_store_dword v92, v146, s[8:11], s65 offen sc1
    s_mov_b64 exec, -1
L_ng1:
    s_barrier
    s_cmp_eq_u32 s57, 0
    s_cbranch_scc1 L_nog2
    s_cmp_lg_u32 s51, 0
    s_cbranch_scc1 L_skip_cf0False
    buffer_load_dwordx4 v[16:19], v141, s[8:11], s74 offen offset:0 sc1
    buffer_load_dwordx4 v[20:23], v141, s[8:11], s74 offen offset:32 sc1
    buffer_load_dwordx4 v[24:27], v141, s[8:11], s74 offen offset:1024 sc1
    buffer_load_dwordx4 v[28:31], v141, s[8:11], s74 offen offset:1056 sc1
L_skip_cf0False:
    buffer_load_dwordx2 v[108:109], v149, s[8:11], s75 offen sc1
    s_add_u32 s53, s73, 8192
    buffer_load_dwordx4 v[0:3], v140, s[8:11], s73 offen offset:0 sc1
    buffer_load_dwordx4 v[4:7], v140, s[8:11], s73 offen offset:256 sc1
    buffer_load_dwordx4 v[8:11], v140, s[8:11], s53 offen offset:0 sc1
    buffer_load_dwordx4 v[12:15], v140, s[8:11], s53 offen offset:256 sc1
L_pm_h:
    s_waitcnt vmcnt(4)
    v_mfma_f32_16x16x4_f32 v[100:103], v148, v108, 0
    v_mfma_f32_16x16x4_f32 v[104:107], v148, v109, 0
    s_cmp_lg_u32 s51, 0
    s_cbranch_scc1 L_skip_cf
    v_mfma_f32_16x16x32_bf16 v[180:183], v[88:91], v[16:19], 0
    v_mfma_f32_16x16x32_bf16 v[184:187], v[88:91], v[20:23], 0
    v_mfma_f32_16x16x32_bf16 v[180:183], v[88:91], v[24:27], v[180:183]
    v_mfma_f32_16x16x32_bf16 v[184:187], v[88:91], v[28:31], v[184:187]
L_skip_cf:
    s_nop 7
    v_add_f32_dpp v100, v100, v100 row_ror:8 row_mask:0xf bank_mask:0xf
    v_add_f32_dpp v104, v104, v104 row_ror:8 row_mask:0xf bank_mask:0xf
    s_mov_b32 s53, 0x3a800000
    v_mul_f32 v100, s53, v100
    v_mul_f32 v104, s53, v104
    v_fma_f32 v104, -v100, v100, v104
    v_max_f32 v104, 0, v104
    v_add_f32 v104, 0x3727c5ac, v104
    v_rsq_f32 v104, v104
    v_add_f32 v110, v105, v101
    v_mul_f32 v92, -v100, v180
    v_mul_f32 v93, -v100, v181
    v_mul_f32 v94, -v100, v182
    v_mul_f32 v95, -v100, v183
    v_mul_f32 v96, -v100, v184
    v_mul_f32 v97, -v100, v185
    v_mul_f32 v98, -v100, v186
    v_mul_f32 v99, -v100, v187
    s_nop 0
    s_waitcnt vmcnt(3)
    v_mfma_f32_16x16x32_bf16 v[92:95], v[88:91], v[0:3], v[92:95]
    s_waitcnt vmcnt(2)
    v_mfma_f32_16x16x32_bf16 v[96:99], v[88:91], v[4:7], v[96:99]
    s_waitcnt vmcnt(1)
    v_mfma_f32_16x16x32_bf16 v[92:95], v[88:91], v[8:11], v[92:95]
    s_waitcnt vmcnt(0)
    v_mfma_f32_16x16x32_bf16 v[96:99], v[88:91], v[12:15], v[96:99]
    s_nop 7
    v_cmp_u_f32 s[78:79], v92, v96
    v_cmp_u_f32 vcc, v110, v110
    s_or_b64 s[78:79], s[78:79], vcc
    s_cmp_lg_u64 s[78:79], 0
    s_cbranch_scc1 L_rt_h
L_pd_h:
    v_add_f32_dpp v92, v92, v92 row_ror:8 row_mask:0xf bank_mask:0xf
    v_add_f32_dpp v93, v93, v93 row_ror:8 row_mask:0xf bank_mask:0xf
    v_add_f32_dpp v94, v94, v94 row_ror:8 row_mask:0xf bank_mask:0xf
    v_add_f32_dpp v95, v95, v95 row_ror:8 row_mask:0xf bank_mask:0xf
    v_add_f32_dpp v96, v96, v96 row_ror:8 row_mask:0xf bank_mask:0xf
    v_add_f32_dpp v97, v97, v97 row_ror:8 row_mask:0xf bank_mask:0xf
    v_add_f32_dpp v98, v98, v98 row_ror:8 row_mask:0xf bank_mask:0xf
    v_add_f32_dpp v99, v99, v99 row_ror:8 row_mask:0xf bank_mask:0xf
    s_mov_b32 s53, 0xbfb8aa3b
    v_mul_f32 v92, v104, v92
    v_mul_f32 v93, v104, v93
    v_mul_f32 v94, v104, v94
    v_mul_f32 v95, v104, v95
    v_mul_f32 v96, v104, v96
    v_mul_f32 v97, v104, v97
    v_mul_f32 v98, v104, v98
    v_mul_f32 v99, v104, v99
    v_mul_f32 v160, s53, v92
    v_mul_f32 v161, s53, v93
    v_mul_f32 v162, s53, v94
    v_mul_f32 v163, s53, v95
    v_mul_f32 v164, s53, v96
    v_mul_f32 v165, s53, v97
    v_mul_f32 v166, s53, v98
    v_mul_f32 v167, s53, v99
    v_exp_f32 v160, v160
    v_exp_f32 v161, v161
    v_exp_f32 v162, v162
    v_exp_f32 v163, v163
    v_exp_f32 v164, v164
    v_exp_f32 v165, v165
    v_exp_f32 v166, v166
    v_exp_f32 v167, v167
    v_add_f32 v160, 1.0, v160
    v_add_f32 v161, 1.0, v161
    v_add_f32 v162, 1.0, v162
    v_add_f32 v163, 1.0, v163
    v_add_f32 v164, 1.0, v164
    v_add_f32 v165, 1.0, v165
    v_add_f32 v166, 1.0, v166
    v_add_f32 v167, 1.0, v167
    v_rcp_f32 v160, v160
    v_rcp_f32 v161, v161
    v_rcp_f32 v162, v162
    v_rcp_f32 v163, v163
    v_rcp_f32 v164, v164
    v_rcp_f32 v165, v165
    v_rcp_f32 v166, v166
    v_rcp_f32 v167, v167
    v_mul_f32 v92, v160, v92
    v_mul_f32 v93, v161, v93
    v_mul_f32 v94, v162, v94
    v_mul_f32 v95, v163, v95
    v_mul_f32 v96, v164, v96
    v_mul_f32 v97, v165, v97
    v_mul_f32 v98, v166, v98
    v_mul_f32 v99, v167, v99
    v_cvt_pk_bf16_f32 v116, v92, v93
    v_cvt_pk_bf16_f32 v117, v94, v95
    v_cvt_pk_bf16_f32 v118, v96, v97
    v_cvt_pk_bf16_f32 v119, v98, v99
    ds_write_b128 v150, v[116:119] offset:16384
    s_waitcnt lgkmcnt(0)
L_nog2:
    s_barrier
    s_barrier
    s_add_u32 s64, s64, 0x300000
    s_add_u32 s65, s65, 0x300000
    s_add_u32 s66, s66, 0x300000
    s_add_u32 s67, s67, 0x300000
    s_add_u32 s68, s68, 0x300000
    s_add_u32 s69, s69, 0x300000
    s_add_u32 s70, s70, 0x300000
    s_add_u32 s71, s71, 0x300000
    s_add_u32 s72, s72, 0x300000
    s_add_u32 s73, s73, 0x300000
    s_add_u32 s74, s74, 0x300000
    s_add_u32 s75, s75, 0x300000
    s_add_u32 s51, s51, 1
    s_cmp_lt_u32 s51, 2
    s_cbranch_scc1 L_nf
    s_cmp_lg_u32 s50, s48
    s_cbranch_scc1 L_fin
L_nf:
    s_mov_b32 s53, s66
    buffer_load_dwordx4 v[0:3], v140, s[8:11], s53 offen offset:0 sc1
    buffer_load_dwordx4 v[4:7], v140, s[8:11], s53 offen offset:256 sc1
    s_add_u32 s53, s53, 8192
    buffer_load_dwordx4 v[8:11], v140, s[8:11], s53 offen offset:0 sc1
    buffer_load_dwordx4 v[12:15], v140, s[8:11], s53 offen offset:256 sc1
    s_add_u32 s53, s53, 8192
    buffer_load_dwordx4 v[16:19], v140, s[8:11], s53 offen offset:0 sc1
    buffer_load_dwordx4 v[20:23], v140, s[8:11], s53 offen offset:256 sc1
    s_add_u32 s53, s53, 8192
    buffer_load_dwordx4 v[24:27], v140, s[8:11], s53 offen offset:0 sc1
    buffer_load_dwordx4 v[28:31], v140, s[8:11], s53 offen offset:256 sc1
    s_add_u32 s53, s53, 8192
    buffer_load_dwordx4 v[32:35], v140, s[8:11], s53 offen offset:0 sc1
    buffer_load_dwordx4 v[36:39], v140, s[8:11], s53 offen offset:256 sc1
    s_add_u32 s53, s53, 8192
    buffer_load_dwordx4 v[40:43], v140, s[8:11], s53 offen offset:0 sc1
    buffer_load_dwordx4 v[44:47], v140, s[8:11], s53 offen offset:256 sc1
    s_add_u32 s53, s53, 8192
    buffer_load_dwordx4 v[48:51], v140, s[8:11], s53 offen offset:0 sc1
    buffer_load_dwordx4 v[52:55], v140, s[8:11], s53 offen offset:256 sc1
L_pm_f2:
    s_waitcnt vmcnt(13)
    v_mfma_f32_16x16x32_bf16 v[92:95], v[88:91], v[0:3], 0
    s_waitcnt vmcnt(12)
    v_mfma_f32_16x16x32_bf16 v[96:99], v[88:91], v[4:7], 0
    s_waitcnt vmcnt(11)
    v_mfma_f32_16x16x32_bf16 v[92:95], v[88:91], v[8:11], v[92:95]
    s_waitcnt vmcnt(10)
    v_mfma_f32_16x16x32_bf16 v[96:99], v[88:91], v[12:15], v[96:99]
    s_waitcnt vmcnt(9)
    v_mfma_f32_16x16x32_bf16 v[92:95], v[88:91], v[16:19], v[92:95]
    s_waitcnt vmcnt(8)
    v_mfma_f32_16x16x32_bf16 v[96:99], v[88:91], v[20:23], v[96:99]
    s_waitcnt vmcnt(7)
    v_mfma_f32_16x16x32_bf16 v[92:95], v[88:91], v[24:27], v[92:95]
    s_waitcnt vmcnt(6)
    v_mfma_f32_16x16x32_bf16 v[96:99], v[88:91], v[28:31], v[96:99]
    s_waitcnt vmcnt(5)
    v_mfma_f32_16x16x32_bf16 v[92:95], v[88:91], v[32:35], v[92:95]
    s_waitcnt vmcnt(4)
    v_mfma_f32_16x16x32_bf16 v[96:99], v[88:91], v[36:39], v[96:99]
    s_waitcnt vmcnt(3)
    v_mfma_f32_16x16x32_bf16 v[92:95], v[88:91], v[40:43], v[92:95]
    s_waitcnt vmcnt(2)
    v_mfma_f32_16x16x32_bf16 v[96:99], v[88:91], v[44:47], v[96:99]
    s_waitcnt vmcnt(1)
    v_mfma_f32_16x16x32_bf16 v[92:95], v[88:91], v[48:51], v[92:95]
    s_waitcnt vmcnt(0)
    v_mfma_f32_16x16x32_bf16 v[96:99], v[88:91], v[52:55], v[96:99]
    s_nop 7
    v_cmp_u_f32 s[78:79], v92, v96
    s_cmp_lg_u64 s[78:79], 0
    s_cbranch_scc1 L_rt_f2
L_pd_f2:
    v_add_f32_dpp v92, v92, v92 row_ror:8 row_mask:0xf bank_mask:0xf
    v_add_f32_dpp v93, v93, v93 row_ror:8 row_mask:0xf bank_mask:0xf
    v_add_f32_dpp v94, v94, v94 row_ror:8 row_mask:0xf bank_mask:0xf
    v_add_f32_dpp v95, v95, v95 row_ror:8 row_mask:0xf bank_mask:0xf
    v_add_f32_dpp v96, v96, v96 row_ror:8 row_mask:0xf bank_mask:0xf
    v_add_f32_dpp v97, v97, v97 row_ror:8 row_mask:0xf bank_mask:0xf
    v_add_f32_dpp v98, v98, v98 row_ror:8 row_mask:0xf bank_mask:0xf
    v_add_f32_dpp v99, v99, v99 row_ror:8 row_mask:0xf bank_mask:0xf
    v_add_f32 v92, v92, v64
    v_add_f32 v93, v93, v65
    v_add_f32 v94, v94, v66
    v_add_f32 v95, v95, v67
    v_add_f32 v96, v96, v68
    v_add_f32 v97, v97, v69
    v_add_f32 v98, v98, v70
    v_add_f32 v99, v99, v71
    v_cvt_pk_bf16_f32 v116, v92, v93
    v_cvt_pk_bf16_f32 v117, v94, v95
    v_cvt_pk_bf16_f32 v118, v96, v97
    v_cvt_pk_bf16_f32 v119, v98, v99
    s_cmp_lt_u32 s51, 2
    s_cbranch_scc1 L_x0
    s_mov_b32 exec_lo, 0xff00ff
    s_mov_b32 exec_hi, 0xff00ff
    buffer_store_dwordx2 v[116:117], v147, s[40:43], 0 offen
    buffer_store_dwordx2 v[118:119], v147, s[40:43], 0 offen offset:32
    s_mov_b64 exec, -1
L_fin:
L_end:
    s_endpgm
L_wt:
    s_lshl_b32 s53, s48, 6
    v_lshl_add_u32 v249, v250, 4, s53
    s_lshl_b32 s53, s48, 9
    v_lshl_add_u32 v254, v251, 6, s53
    v_lshl_add_u32 v254, v250, 4, v254
    v_lshl_add_u32 v253, v250, 7, s53
    v_lshl_add_u32 v253, v251, 4, v253
    s_mul_i32 s53, s6, 1792
    s_sub_u32 s53, 0x1a8000, s53
    s_mov_b32 exec_lo, 0x1000100
    s_mov_b32 exec_hi, 0x1000100
    v_add_u32 v253, s53, v249
    s_mul_i32 s53, s2, 1792
    s_sub_u32 s53, 0x80000, s53
    v_add_u32 v254, s53, v249
    s_mov_b64 exec, -1
    s_mov_b32 s76, 0x01FF01FF
    s_waitcnt lgkmcnt(0)
L_wloop:
    s_cmp_lg_u32 s51, 0
    s_cbranch_scc1 L_skip_wq
    s_mul_i32 s53, s48, 8704
    s_add_u32 s53, s53, 25600
    v_add_u32 v216, s53, v255
    v_lshrrev_b32 v217, 2, v251
    v_lshl_add_u32 v217, v250, 2, v217
    v_lshlrev_b32 v217, 6, v217
    v_and_b32 v218, 3, v252
    v_lshl_add_u32 v217, v218, 4, v217
    v_add_u32 v217, s53, v217
    s_waitcnt vmcnt(0)
    s_mov_b32 s53, 0xc0000
    s_lshl_b32 s54, s49, 22
    s_add_u32 s53, s53, s54
    s_lshl_b32 s54, s4, 20
    s_add_u32 s53, s53, s54
    s_lshl_b32 s54, s5, 15
    s_add_u32 s53, s53, s54
    s_lshl_b32 s54, s48, 13
    s_add_u32 s53, s53, s54
    buffer_load_dwordx4 v[32:35], v255, s[16:19], s53 offen
    s_add_u32 s53, s53, 1024
    buffer_load_dwordx4 v[36:39], v255, s[16:19], s53 offen
    s_add_u32 s53, s53, 1024
    buffer_load_dwordx4 v[40:43], v255, s[16:19], s53 offen
    s_add_u32 s53, s53, 1024
    buffer_load_dwordx4 v[44:47], v255, s[16:19], s53 offen
    s_add_u32 s53, s53, 1024
    buffer_load_dwordx4 v[48:51], v255, s[16:19], s53 offen
    s_add_u32 s53, s53, 1024
    buffer_load_dwordx4 v[52:55], v255, s[16:19], s53 offen
    s_add_u32 s53, s53, 1024
    buffer_load_dwordx4 v[56:59], v255, s[16:19], s53 offen
    s_add_u32 s53, s53, 1024
    buffer_load_dwordx4 v[60:63], v255, s[16:19], s53 offen
    ds_write_b128 v216, v[0:3] offset:0
    ds_write_b128 v216, v[4:7] offset:1024
    ds_write_b128 v216, v[8:11] offset:2048
    ds_write_b128 v216, v[12:15] offset:3072
    ds_write_b128 v216, v[16:19] offset:4096
    ds_write_b128 v216, v[20:23] offset:5120
    ds_write_b128 v216, v[24:27] offset:6144
    ds_write_b128 v216, v[28:31] offset:7168
    s_waitcnt lgkmcnt(0)
    ds_read_b64_tr_b16 v[0:1], v217 offset:0
    ds_read_b64_tr_b16 v[2:3], v217 offset:1024
    ds_read_b64_tr_b16 v[4:5], v217 offset:2048
    ds_read_b64_tr_b16 v[6:7], v217 offset:3072
    ds_read_b64_tr_b16 v[8:9], v217 offset:4096
    ds_read_b64_tr_b16 v[10:11], v217 offset:5120
    ds_read_b64_tr_b16 v[12:13], v217 offset:6144
    ds_read_b64_tr_b16 v[14:15], v217 offset:7168
    ds_read_b64_tr_b16 v[16:17], v217 offset:8
    ds_read_b64_tr_b16 v[18:19], v217 offset:1032
    ds_read_b64_tr_b16 v[20:21], v217 offset:2056
    ds_read_b64_tr_b16 v[22:23], v217 offset:3080
    ds_read_b64_tr_b16 v[24:25], v217 offset:4104
    ds_read_b64_tr_b16 v[26:27], v217 offset:5128
    ds_read_b64_tr_b16 v[28:29], v217 offset:6152
    ds_read_b64_tr_b16 v[30:31], v217 offset:7176
    s_waitcnt lgkmcnt(0)
L_skip_wq:
    s_barrier
    ds_read_b128 v[192:195], v255 offset:0
    ds_read_b128 v[196:199], v255 offset:1024
    ds_read_b128 v[200:203], v255 offset:2048
    ds_read_b128 v[204:207], v255 offset:3072
    s_waitcnt lgkmcnt(3)
    v_mfma_f32_16x16x32_bf16 v[208:211], v[0:3], v[192:195], 0
    v_mfma_f32_16x16x32_bf16 v[212:215], v[16:19], v[192:195], 0
    s_waitcnt lgkmcnt(2)
    v_mfma_f32_16x16x32_bf16 v[208:211], v[4:7], v[196:199], v[208:211]
    v_mfma_f32_16x16x32_bf16 v[212:215], v[20:23], v[196:199], v[212:215]
    s_waitcnt lgkmcnt(1)
    v_mfma_f32_16x16x32_bf16 v[208:211], v[8:11], v[200:203], v[208:211]
    v_mfma_f32_16x16x32_bf16 v[212:215], v[24:27], v[200:203], v[212:215]
    s_waitcnt lgkmcnt(0)
    v_mfma_f32_16x16x32_bf16 v[208:211], v[12:15], v[204:207], v[208:211]
    v_mfma_f32_16x16x32_bf16 v[212:215], v[28:31], v[204:207], v[212:215]
    s_nop 7
    v_cvt_pk_bf16_f32 v216, v208, v209
    v_cvt_pk_bf16_f32 v217, v210, v211
    v_cvt_pk_bf16_f32 v218, v212, v213
    v_cvt_pk_bf16_f32 v219, v214, v215
    s_mov_b32 exec_lo, s76
    s_mov_b32 exec_hi, s76
    buffer_store_dwordx4 v[216:219], v254, s[8:11], s58 offen sc1
    s_mov_b64 exec, -1
    s_cmp_eq_u32 s51, 0
    s_cbranch_scc1 L_na_q
    s_waitcnt vmcnt(0)
    s_barrier
L_na_q:
    s_cmp_lg_u32 s51, 0
    s_cbranch_scc1 L_skip_k
    s_mul_i32 s53, s48, 8704
    s_add_u32 s53, s53, 25600
    v_mul_u32_u24 v216, 272, v250
    v_lshl_add_u32 v216, v251, 4, v216
    v_add_u32 v216, s53, v216
    v_mul_u32_u24 v217, 272, v251
    v_lshl_add_u32 v217, v250, 4, v217
    v_add_u32 v217, s53, v217
    v_lshrrev_b32 v210, 2, v252
    v_mul_u32_u24 v210, 256, v210
    v_and_b32 v211, 3, v252
    v_lshl_add_u32 v210, v211, 4, v210
    s_lshl_b32 s54, s48, 6
    v_add_u32 v210, s54, v210
    s_mov_b32 s53, 0xc0000
    s_lshl_b32 s54, s49, 22
    s_add_u32 s53, s53, s54
    s_lshl_b32 s54, s4, 20
    s_add_u32 s53, s53, s54
    s_lshl_b32 s54, s5, 15
    s_add_u32 s53, s53, s54
    buffer_load_dwordx4 v[64:67], v210, s[20:23], s53 offen
    s_add_u32 s53, s53, 4096
    buffer_load_dwordx4 v[68:71], v210, s[20:23], s53 offen
    s_add_u32 s53, s53, 4096
    buffer_load_dwordx4 v[72:75], v210, s[20:23], s53 offen
    s_add_u32 s53, s53, 4096
    buffer_load_dwordx4 v[76:79], v210, s[20:23], s53 offen
    s_add_u32 s53, s53, 4096
    buffer_load_dwordx4 v[80:83], v210, s[20:23], s53 offen
    s_add_u32 s53, s53, 4096
    buffer_load_dwordx4 v[84:87], v210, s[20:23], s53 offen
    s_add_u32 s53, s53, 4096
    buffer_load_dwordx4 v[88:91], v210, s[20:23], s53 offen
    s_add_u32 s53, s53, 4096
    buffer_load_dwordx4 v[92:95], v210, s[20:23], s53 offen
    s_waitcnt vmcnt(9)
    ds_write_b128 v216, v[32:35] offset:0
    ds_write_b128 v216, v[36:39] offset:1088
    ds_write_b128 v216, v[40:43] offset:2176
    ds_write_b128 v216, v[44:47] offset:3264
    ds_write_b128 v216, v[48:51] offset:4352
    ds_write_b128 v216, v[52:55] offset:5440
    ds_write_b128 v216, v[56:59] offset:6528
    ds_write_b128 v216, v[60:63] offset:7616
    s_waitcnt lgkmcnt(0)
    s_barrier
    ds_read_b128 v[32:35], v217 offset:0
    ds_read_b128 v[36:39], v217 offset:64
    ds_read_b128 v[40:43], v217 offset:128
    ds_read_b128 v[44:47], v217 offset:192
    ds_read_b128 v[48:51], v217 offset:4352
    ds_read_b128 v[52:55], v217 offset:4416
    ds_read_b128 v[56:59], v217 offset:4480
    ds_read_b128 v[60:63], v217 offset:4544
    s_waitcnt lgkmcnt(0)
    s_mul_i32 s53, s48, 8704
    s_add_u32 s53, s53, 25600
    v_add_u32 v216, s53, v255
    v_lshrrev_b32 v217, 2, v251
    v_lshl_add_u32 v217, v250, 2, v217
    v_lshlrev_b32 v217, 6, v217
    v_and_b32 v218, 3, v252
    v_lshl_add_u32 v217, v218, 4, v217
    v_add_u32 v217, s53, v217
    s_waitcnt vmcnt(0)
    s_barrier
    v_lshrrev_b32 v212, 2, v252
    v_mul_u32_u24 v212, 2048, v212
    v_and_b32 v213, 3, v252
    v_lshl_add_u32 v212, v213, 4, v212
    s_lshl_b32 s54, s48, 6
    v_add_u32 v212, s54, v212
    s_mov_b32 s53, 0x0
    s_lshl_b32 s54, s55, 18
    s_add_u32 s53, s53, s54
    s_lshl_b32 s54, s5, 8
    s_add_u32 s53, s53, s54
    s_xor_b32 s53, s53, 0x200
    buffer_load_dwordx4 v[96:99], v212, s[24:27], s53 offen
    s_add_u32 s53, s53, 32768
    buffer_load_dwordx4 v[100:103], v212, s[24:27], s53 offen
    s_add_u32 s53, s53, 32768
    buffer_load_dwordx4 v[104:107], v212, s[24:27], s53 offen
    s_add_u32 s53, s53, 32768
    buffer_load_dwordx4 v[108:111], v212, s[24:27], s53 offen
    s_add_u32 s53, s53, 32768
    buffer_load_dwordx4 v[112:115], v212, s[24:27], s53 offen
    s_add_u32 s53, s53, 32768
    buffer_load_dwordx4 v[116:119], v212, s[24:27], s53 offen
    s_add_u32 s53, s53, 32768
    buffer_load_dwordx4 v[120:123], v212, s[24:27], s53 offen
    s_add_u32 s53, s53, 32768
    buffer_load_dwordx4 v[124:127], v212, s[24:27], s53 offen
    ds_write_b128 v216, v[64:67] offset:0
    ds_write_b128 v216, v[68:71] offset:1024
    ds_write_b128 v216, v[72:75] offset:2048
    ds_write_b128 v216, v[76:79] offset:3072
    ds_write_b128 v216, v[80:83] offset:4096
    ds_write_b128 v216, v[84:87] offset:5120
    ds_write_b128 v216, v[88:91] offset:6144
    ds_write_b128 v216, v[92:95] offset:7168
    s_waitcnt lgkmcnt(0)
    ds_read_b64_tr_b16 v[64:65], v217 offset:0
    ds_read_b64_tr_b16 v[66:67], v217 offset:1024
    ds_read_b64_tr_b16 v[68:69], v217 offset:2048
    ds_read_b64_tr_b16 v[70:71], v217 offset:3072
    ds_read_b64_tr_b16 v[72:73], v217 offset:4096
    ds_read_b64_tr_b16 v[74:75], v217 offset:5120
    ds_read_b64_tr_b16 v[76:77], v217 offset:6144
    ds_read_b64_tr_b16 v[78:79], v217 offset:7168
    ds_read_b64_tr_b16 v[80:81], v217 offset:8
    ds_read_b64_tr_b16 v[82:83], v217 offset:1032
    ds_read_b64_tr_b16 v[84:85], v217 offset:2056
    ds_read_b64_tr_b16 v[86:87], v217 offset:3080
    ds_read_b64_tr_b16 v[88:89], v217 offset:4104
    ds_read_b64_tr_b16 v[90:91], v217 offset:5128
    ds_read_b64_tr_b16 v[92:93], v217 offset:6152
    ds_read_b64_tr_b16 v[94:95], v217 offset:7176
    s_waitcnt lgkmcnt(0)
L_skip_k:
    s_barrier
    ds_read_b128 v[192:195], v255 offset:4096
    ds_read_b128 v[196:199], v255 offset:5120
    ds_read_b128 v[200:203], v255 offset:6144
    ds_read_b128 v[204:207], v255 offset:7168
    s_waitcnt lgkmcnt(3)
    v_mfma_f32_16x16x32_bf16 v[208:211], v[32:35], v[192:195], 0
    v_mfma_f32_16x16x32_bf16 v[212:215], v[48:51], v[192:195], 0
    s_waitcnt lgkmcnt(2)
    v_mfma_f32_16x16x32_bf16 v[208:211], v[36:39], v[196:199], v[208:211]
    v_mfma_f32_16x16x32_bf16 v[212:215], v[52:55], v[196:199], v[212:215]
    s_waitcnt lgkmcnt(1)
    v_mfma_f32_16x16x32_bf16 v[208:211], v[40:43], v[200:203], v[208:211]
    v_mfma_f32_16x16x32_bf16 v[212:215], v[56:59], v[200:203], v[212:215]
    s_waitcnt lgkmcnt(0)
    v_mfma_f32_16x16x32_bf16 v[208:211], v[44:47], v[204:207], v[208:211]
    v_mfma_f32_16x16x32_bf16 v[212:215], v[60:63], v[204:207], v[212:215]
    s_mov_b32 s53, 0x3e0293ee
    s_nop 6
    v_max3_f32 v216, v208, v209, v210
    v_max3_f32 v217, v211, v212, v213
    v_max3_f32 v216, v216, v214, v215
    v_max_f32 v216, v216, v217
    v_mov_b32 v217, v216
    s_nop 1
    v_permlane16_swap_b32 v216, v217
    v_max_f32 v216, v216, v217
    v_mov_b32 v217, v216
    s_nop 1
    v_permlane32_swap_b32 v216, v217
    v_max_f32 v216, v216, v217
    v_mul_f32 v216, s53, v216
    v_fma_f32 v208, v208, s53, -v216
    v_fma_f32 v209, v209, s53, -v216
    v_fma_f32 v210, v210, s53, -v216
    v_fma_f32 v211, v211, s53, -v216
    v_fma_f32 v212, v212, s53, -v216
    v_fma_f32 v213, v213, s53, -v216
    v_fma_f32 v214, v214, s53, -v216
    v_fma_f32 v215, v215, s53, -v216
    v_exp_f32 v208, v208
    v_exp_f32 v209, v209
    v_exp_f32 v210, v210
    v_exp_f32 v211, v211
    v_exp_f32 v212, v212
    v_exp_f32 v213, v213
    v_exp_f32 v214, v214
    v_exp_f32 v215, v215
    s_nop 0
    v_cvt_pk_bf16_f32 v220, v208, v209
    v_cvt_pk_bf16_f32 v221, v210, v211
    v_cvt_pk_bf16_f32 v222, v212, v213
    v_cvt_pk_bf16_f32 v223, v214, v215
    s_lshl_b32 s53, s48, 10
    v_add_u32 v218, s53, v255
    ds_write_b128 v218, v[220:223] offset:20480
    v_add_f32 v208, v208, v209
    v_add_f32 v210, v210, v211
    v_add_f32 v212, v212, v213
    v_add_f32 v214, v214, v215
    v_add_f32 v208, v208, v210
    v_add_f32 v212, v212, v214
    v_add_f32 v217, v208, v212
    v_mov_b32 v219, v217
    s_nop 1
    v_permlane16_swap_b32 v217, v219
    v_add_f32 v217, v217, v219
    v_mov_b32 v219, v217
    s_nop 1
    v_permlane32_swap_b32 v217, v219
    v_add_f32 v217, v217, v219
    s_lshl_b32 s53, s48, 3
    v_lshl_add_u32 v218, v251, 5, s53
    s_mov_b32 exec_lo, 0xffff
    s_mov_b32 exec_hi, 0x0
    ds_write_b64 v218, v[216:217] offset:24576
    s_mov_b64 exec, -1
    s_waitcnt lgkmcnt(0)
    s_barrier
    v_lshlrev_b32 v249, 5, v251
    ds_read_b128 v[192:195], v255 offset:20480
    ds_read_b128 v[196:199], v255 offset:21504
    ds_read_b128 v[200:203], v255 offset:22528
    ds_read_b128 v[204:207], v255 offset:23552
    ds_read_b128 v[240:243], v249 offset:24576
    ds_read_b128 v[244:247], v249 offset:24592
    s_waitcnt lgkmcnt(5)
    v_mfma_f32_16x16x32_bf16 v[208:211], v[64:67], v[192:195], 0
    v_mfma_f32_16x16x32_bf16 v[212:215], v[80:83], v[192:195], 0
    s_waitcnt lgkmcnt(4)
    v_mfma_f32_16x16x32_bf16 v[216:219], v[68:71], v[196:199], 0
    v_mfma_f32_16x16x32_bf16 v[220:223], v[84:87], v[196:199], 0
    s_waitcnt lgkmcnt(3)
    v_mfma_f32_16x16x32_bf16 v[224:227], v[72:75], v[200:203], 0
    v_mfma_f32_16x16x32_bf16 v[228:231], v[88:91], v[200:203], 0
    s_waitcnt lgkmcnt(2)
    v_mfma_f32_16x16x32_bf16 v[232:235], v[76:79], v[204:207], 0
    v_mfma_f32_16x16x32_bf16 v[236:239], v[92:95], v[204:207], 0
    s_waitcnt lgkmcnt(0)
    v_max3_f32 v248, v240, v242, v244
    v_max_f32 v248, v248, v246
    v_sub_f32 v240, v240, v248
    v_sub_f32 v242, v242, v248
    v_sub_f32 v244, v244, v248
    v_sub_f32 v246, v246, v248
    v_exp_f32 v240, v240
    v_exp_f32 v242, v242
    v_exp_f32 v244, v244
    v_exp_f32 v246, v246
    s_nop 0
    v_mul_f32 v249, v240, v241
    v_fmac_f32 v249, v242, v243
    v_fmac_f32 v249, v244, v245
    v_fmac_f32 v249, v246, v247
    v_mul_f32 v208, v240, v208
    v_mul_f32 v209, v240, v209
    v_mul_f32 v210, v240, v210
    v_mul_f32 v211, v240, v211
    v_mul_f32 v212, v240, v212
    v_mul_f32 v213, v240, v213
    v_mul_f32 v214, v240, v214
    v_mul_f32 v215, v240, v215
    v_fmac_f32 v208, v242, v216
    v_fmac_f32 v209, v242, v217
    v_fmac_f32 v210, v242, v218
    v_fmac_f32 v211, v242, v219
    v_fmac_f32 v212, v242, v220
    v_fmac_f32 v213, v242, v221
    v_fmac_f32 v214, v242, v222
    v_fmac_f32 v215, v242, v223
    v_fmac_f32 v208, v244, v224
    v_fmac_f32 v209, v244, v225
    v_fmac_f32 v210, v244, v226
    v_fmac_f32 v211, v244, v227
    v_fmac_f32 v212, v244, v228
    v_fmac_f32 v213, v244, v229
    v_fmac_f32 v214, v244, v230
    v_fmac_f32 v215, v244, v231
    v_fmac_f32 v208, v246, v232
    v_fmac_f32 v209, v246, v233
    v_fmac_f32 v210, v246, v234
    v_fmac_f32 v211, v246, v235
    v_fmac_f32 v212, v246, v236
    v_fmac_f32 v213, v246, v237
    v_fmac_f32 v214, v246, v238
    v_fmac_f32 v215, v246, v239
    v_cvt_pk_bf16_f32 v216, v208, v209
    v_cvt_pk_bf16_f32 v217, v210, v211
    v_cvt_pk_bf16_f32 v218, v212, v213
    v_cvt_pk_bf16_f32 v219, v214, v215
    s_mov_b32 exec_lo, 0xff00ff
    s_mov_b32 exec_hi, 0xff00ff
    buffer_store_dwordx4 v[216:219], v254, s[8:11], s59 offen sc1
    s_mov_b64 exec, -1
    s_lshl_b32 s53, s48, 30
    v_lshl_add_u32 v240, v251, 3, s53
    s_mov_b32 exec_lo, 0xff
    s_mov_b32 exec_hi, 0x0
    buffer_store_dwordx2 v[248:249], v240, s[8:11], s60 offen sc1
    s_mov_b64 exec, -1
    s_cmp_eq_u32 s51, 0
    s_cbranch_scc1 L_na_a
    s_waitcnt vmcnt(0)
    s_barrier
L_na_a:
    s_cmp_lg_u32 s51, 0
    s_cbranch_scc1 L_skip_wo
    s_mul_i32 s53, s48, 8704
    s_add_u32 s53, s53, 25600
    v_add_u32 v216, s53, v255
    v_lshrrev_b32 v217, 2, v251
    v_lshl_add_u32 v217, v250, 3, v217
    v_lshlrev_b32 v217, 6, v217
    v_and_b32 v218, 3, v252
    v_lshl_add_u32 v217, v218, 4, v217
    v_add_u32 v217, s53, v217
    s_waitcnt vmcnt(2)
    v_lshrrev_b32 v214, 2, v252
    v_mul_u32_u24 v214, 7168, v214
    v_and_b32 v215, 3, v252
    v_lshl_add_u32 v214, v215, 4, v214
    s_lshl_b32 s54, s48, 6
    v_add_u32 v214, s54, v214
    s_mul_i32 s53, s49, 917504
    s_lshr_b32 s54, s6, 3
    s_lshl_b32 s54, s54, 8
    s_add_u32 s53, s53, s54
    s_cmp_eq_u32 s56, 1
    s_cselect_b32 s53, s53, 0
    s_cselect_b32 s54, 0, 0x40000000
    v_or_b32 v214, s54, v214
    buffer_load_dwordx4 v[128:131], v214, s[28:31], s53 offen
    s_add_u32 s53, s53, 114688
    buffer_load_dwordx4 v[132:135], v214, s[28:31], s53 offen
    s_add_u32 s53, s53, 114688
    buffer_load_dwordx4 v[136:139], v214, s[28:31], s53 offen
    s_add_u32 s53, s53, 114688
    buffer_load_dwordx4 v[140:143], v214, s[28:31], s53 offen
    s_add_u32 s53, s53, 114688
    buffer_load_dwordx4 v[144:147], v214, s[28:31], s53 offen
    s_add_u32 s53, s53, 114688
    buffer_load_dwordx4 v[148:151], v214, s[28:31], s53 offen
    s_add_u32 s53, s53, 114688
    buffer_load_dwordx4 v[152:155], v214, s[28:31], s53 offen
    s_add_u32 s53, s53, 114688
    buffer_load_dwordx4 v[156:159], v214, s[28:31], s53 offen
    ds_write_b128 v216, v[96:99] offset:0
    ds_write_b128 v216, v[100:103] offset:1024
    ds_write_b128 v216, v[104:107] offset:2048
    ds_write_b128 v216, v[108:111] offset:3072
    ds_write_b128 v216, v[112:115] offset:4096
    ds_write_b128 v216, v[116:119] offset:5120
    ds_write_b128 v216, v[120:123] offset:6144
    ds_write_b128 v216, v[124:127] offset:7168
    s_waitcnt lgkmcnt(0)
    ds_read_b64_tr_b16 v[96:97], v217 offset:0
    ds_read_b64_tr_b16 v[98:99], v217 offset:256
    ds_read_b64_tr_b16 v[100:101], v217 offset:2048
    ds_read_b64_tr_b16 v[102:103], v217 offset:2304
    ds_read_b64_tr_b16 v[104:105], v217 offset:4096
    ds_read_b64_tr_b16 v[106:107], v217 offset:4352
    ds_read_b64_tr_b16 v[108:109], v217 offset:6144
    ds_read_b64_tr_b16 v[110:111], v217 offset:6400
    ds_read_b64_tr_b16 v[112:113], v217 offset:8
    ds_read_b64_tr_b16 v[114:115], v217 offset:264
    ds_read_b64_tr_b16 v[116:117], v217 offset:2056
    ds_read_b64_tr_b16 v[118:119], v217 offset:2312
    ds_read_b64_tr_b16 v[120:121], v217 offset:4104
    ds_read_b64_tr_b16 v[122:123], v217 offset:4360
    ds_read_b64_tr_b16 v[124:125], v217 offset:6152
    ds_read_b64_tr_b16 v[126:127], v217 offset:6408
    s_waitcnt lgkmcnt(0)
    s_waitcnt vmcnt(8)
    s_barrier
L_skip_wo:
    s_barrier
    ds_read_b128 v[192:195], v255 offset:8192
    ds_read_b128 v[196:199], v255 offset:9216
    ds_read_b128 v[200:203], v255 offset:10240
    ds_read_b128 v[204:207], v255 offset:11264
    s_waitcnt lgkmcnt(3)
    v_mfma_f32_16x16x32_bf16 v[208:211], v[96:99], v[192:195], 0
    v_mfma_f32_16x16x32_bf16 v[212:215], v[112:115], v[192:195], 0
    s_waitcnt lgkmcnt(2)
    v_mfma_f32_16x16x32_bf16 v[208:211], v[100:103], v[196:199], v[208:211]
    v_mfma_f32_16x16x32_bf16 v[212:215], v[116:119], v[196:199], v[212:215]
    s_waitcnt lgkmcnt(1)
    v_mfma_f32_16x16x32_bf16 v[208:211], v[104:107], v[200:203], v[208:211]
    v_mfma_f32_16x16x32_bf16 v[212:215], v[120:123], v[200:203], v[212:215]
    s_waitcnt lgkmcnt(0)
    v_mfma_f32_16x16x32_bf16 v[208:211], v[108:111], v[204:207], v[208:211]
    v_mfma_f32_16x16x32_bf16 v[212:215], v[124:127], v[204:207], v[212:215]
    s_nop 7
    v_cvt_pk_bf16_f32 v216, v208, v209
    v_cvt_pk_bf16_f32 v217, v210, v211
    v_cvt_pk_bf16_f32 v218, v212, v213
    v_cvt_pk_bf16_f32 v219, v214, v215
    s_mov_b32 exec_lo, 0xff00ff
    s_mov_b32 exec_hi, 0xff00ff
    buffer_store_dwordx4 v[216:219], v253, s[8:11], s61 offen sc1
    s_mov_b64 exec, -1
    s_cmp_eq_u32 s51, 0
    s_cbranch_scc1 L_na_o
    s_waitcnt vmcnt(0)
    s_barrier
L_na_o:
    s_cmp_lg_u32 s51, 0
    s_cbranch_scc1 L_skip_w1
    v_mov_b32 v240, -1
    v_mov_b32 v241, -1
    v_mov_b32 v242, -1
    v_mov_b32 v243, -1
    s_lshl_b32 s53, s6, 2
    s_add_u32 s53, s53, s48
    s_mul_i32 s53, s53, 3072
    s_add_u32 s53, s53, 0x300000
    v_mov_b32 v244, v255
    s_cmp_eq_u32 s56, 1
    s_cselect_b32 s53, s53, 0
    s_cselect_b32 s54, 0, 0x40000000
    v_or_b32 v244, s54, v244
    buffer_store_dwordx4 v[240:243], v244, s[8:11], s53 offen offset:0 sc1
    buffer_store_dwordx4 v[240:243], v244, s[8:11], s53 offen offset:1024 sc1
    buffer_store_dwordx4 v[240:243], v244, s[8:11], s53 offen offset:2048 sc1
    s_mul_i32 s53, s48, 8704
    s_add_u32 s53, s53, 25600
    v_add_u32 v216, s53, v255
    v_lshrrev_b32 v217, 2, v251
    v_lshl_add_u32 v217, v250, 2, v217
    v_lshlrev_b32 v217, 6, v217
    v_and_b32 v218, 3, v252
    v_lshl_add_u32 v217, v218, 4, v217
    v_add_u32 v217, s53, v217
    s_waitcnt vmcnt(4)
    v_lshrrev_b32 v212, 2, v252
    v_mul_u32_u24 v212, 2048, v212
    v_and_b32 v213, 3, v252
    v_lshl_add_u32 v212, v213, 4, v212
    s_lshl_b32 s54, s48, 6
    v_add_u32 v212, s54, v212
    s_lshr_b32 s53, s7, 3
    s_lshl_b32 s53, s53, 18
    s_and_b32 s54, s7, 7
    s_lshl_b32 s54, s54, 8
    s_add_u32 s53, s53, s54
    s_cmp_eq_u32 s57, 1
    s_cselect_b32 s53, s53, 0
    s_cselect_b32 s54, 0, 0x40000000
    v_or_b32 v212, s54, v212
    buffer_load_dwordx4 v[160:163], v212, s[32:35], s53 offen
    s_add_u32 s53, s53, 32768
    buffer_load_dwordx4 v[164:167], v212, s[32:35], s53 offen
    s_add_u32 s53, s53, 32768
    buffer_load_dwordx4 v[168:171], v212, s[32:35], s53 offen
    s_add_u32 s53, s53, 32768
    buffer_load_dwordx4 v[172:175], v212, s[32:35], s53 offen
    s_add_u32 s53, s53, 32768
    buffer_load_dwordx4 v[176:179], v212, s[32:35], s53 offen
    s_add_u32 s53, s53, 32768
    buffer_load_dwordx4 v[180:183], v212, s[32:35], s53 offen
    s_add_u32 s53, s53, 32768
    buffer_load_dwordx4 v[184:187], v212, s[32:35], s53 offen
    s_add_u32 s53, s53, 32768
    buffer_load_dwordx4 v[188:191], v212, s[32:35], s53 offen
    ds_write_b128 v216, v[128:131] offset:0
    ds_write_b128 v216, v[132:135] offset:1024
    ds_write_b128 v216, v[136:139] offset:2048
    ds_write_b128 v216, v[140:143] offset:3072
    ds_write_b128 v216, v[144:147] offset:4096
    ds_write_b128 v216, v[148:151] offset:5120
    ds_write_b128 v216, v[152:155] offset:6144
    ds_write_b128 v216, v[156:159] offset:7168
    s_waitcnt lgkmcnt(0)
    ds_read_b64_tr_b16 v[128:129], v217 offset:0
    ds_read_b64_tr_b16 v[130:131], v217 offset:1024
    ds_read_b64_tr_b16 v[132:133], v217 offset:2048
    ds_read_b64_tr_b16 v[134:135], v217 offset:3072
    ds_read_b64_tr_b16 v[136:137], v217 offset:4096
    ds_read_b64_tr_b16 v[138:139], v217 offset:5120
    ds_read_b64_tr_b16 v[140:141], v217 offset:6144
    ds_read_b64_tr_b16 v[142:143], v217 offset:7168
    ds_read_b64_tr_b16 v[144:145], v217 offset:8
    ds_read_b64_tr_b16 v[146:147], v217 offset:1032
    ds_read_b64_tr_b16 v[148:149], v217 offset:2056
    ds_read_b64_tr_b16 v[150:151], v217 offset:3080
    ds_read_b64_tr_b16 v[152:153], v217 offset:4104
    ds_read_b64_tr_b16 v[154:155], v217 offset:5128
    ds_read_b64_tr_b16 v[156:157], v217 offset:6152
    ds_read_b64_tr_b16 v[158:159], v217 offset:7176
    s_waitcnt lgkmcnt(0)
    s_barrier
    s_waitcnt vmcnt(8)
L_skip_w1:
    s_barrier
    s_cmp_eq_u32 s56, 0
    s_cbranch_scc1 L_nof1
    ds_read_b128 v[192:195], v255 offset:12288
    ds_read_b128 v[196:199], v255 offset:13312
    ds_read_b128 v[200:203], v255 offset:14336
    ds_read_b128 v[204:207], v255 offset:15360
    s_waitcnt lgkmcnt(3)
    v_mfma_f32_16x16x32_bf16 v[208:211], v[128:131], v[192:195], 0
    v_mfma_f32_16x16x32_bf16 v[212:215], v[144:147], v[192:195], 0
    s_waitcnt lgkmcnt(2)
    v_mfma_f32_16x16x32_bf16 v[208:211], v[132:135], v[196:199], v[208:211]
    v_mfma_f32_16x16x32_bf16 v[212:215], v[148:151], v[196:199], v[212:215]
    s_waitcnt lgkmcnt(1)
    v_mfma_f32_16x16x32_bf16 v[208:211], v[136:139], v[200:203], v[208:211]
    v_mfma_f32_16x16x32_bf16 v[212:215], v[152:155], v[200:203], v[212:215]
    s_waitcnt lgkmcnt(0)
    v_mfma_f32_16x16x32_bf16 v[208:211], v[140:143], v[204:207], v[208:211]
    v_mfma_f32_16x16x32_bf16 v[212:215], v[156:159], v[204:207], v[212:215]
    s_nop 7
    v_cvt_pk_bf16_f32 v216, v208, v209
    v_cvt_pk_bf16_f32 v217, v210, v211
    v_cvt_pk_bf16_f32 v218, v212, v213
    v_cvt_pk_bf16_f32 v219, v214, v215
    s_mov_b32 exec_lo, s76
    s_mov_b32 exec_hi, s76
    buffer_store_dwordx4 v[216:219], v253, s[8:11], s62 offen sc1
    s_mov_b64 exec, -1
L_nof1:
    s_cmp_eq_u32 s51, 0
    s_cbranch_scc1 L_na_f
    s_waitcnt vmcnt(0)
    s_barrier
L_na_f:
    s_cmp_lg_u32 s51, 0
    s_cbranch_scc1 L_skip_w2
    s_mul_i32 s53, s48, 8704
    s_add_u32 s53, s53, 25600
    v_add_u32 v216, s53, v255
    v_lshrrev_b32 v217, 2, v251
    v_lshl_add_u32 v217, v250, 2, v217
    v_lshlrev_b32 v217, 6, v217
    v_and_b32 v218, 3, v252
    v_lshl_add_u32 v217, v218, 4, v217
    v_add_u32 v217, s53, v217
    s_waitcnt vmcnt(0)
    ds_write_b128 v216, v[160:163] offset:0
    ds_write_b128 v216, v[164:167] offset:1024
    ds_write_b128 v216, v[168:171] offset:2048
    ds_write_b128 v216, v[172:175] offset:3072
    ds_write_b128 v216, v[176:179] offset:4096
    ds_write_b128 v216, v[180:183] offset:5120
    ds_write_b128 v216, v[184:187] offset:6144
    ds_write_b128 v216, v[188:191] offset:7168
    s_waitcnt lgkmcnt(0)
    ds_read_b64_tr_b16 v[160:161], v217 offset:0
    ds_read_b64_tr_b16 v[162:163], v217 offset:1024
    ds_read_b64_tr_b16 v[164:165], v217 offset:2048
    ds_read_b64_tr_b16 v[166:167], v217 offset:3072
    ds_read_b64_tr_b16 v[168:169], v217 offset:4096
    ds_read_b64_tr_b16 v[170:171], v217 offset:5120
    ds_read_b64_tr_b16 v[172:173], v217 offset:6144
    ds_read_b64_tr_b16 v[174:175], v217 offset:7168
    ds_read_b64_tr_b16 v[176:177], v217 offset:8
    ds_read_b64_tr_b16 v[178:179], v217 offset:1032
    ds_read_b64_tr_b16 v[180:181], v217 offset:2056
    ds_read_b64_tr_b16 v[182:183], v217 offset:3080
    ds_read_b64_tr_b16 v[184:185], v217 offset:4104
    ds_read_b64_tr_b16 v[186:187], v217 offset:5128
    ds_read_b64_tr_b16 v[188:189], v217 offset:6152
    ds_read_b64_tr_b16 v[190:191], v217 offset:7176
    s_waitcnt lgkmcnt(0)
    s_waitcnt vmcnt(0)
    s_barrier
L_skip_w2:
    s_barrier
    s_cmp_eq_u32 s57, 0
    s_cbranch_scc1 L_nof2
    ds_read_b128 v[192:195], v255 offset:16384
    ds_read_b128 v[196:199], v255 offset:17408
    ds_read_b128 v[200:203], v255 offset:18432
    ds_read_b128 v[204:207], v255 offset:19456
    s_waitcnt lgkmcnt(3)
    v_mfma_f32_16x16x32_bf16 v[208:211], v[160:163], v[192:195], 0
    v_mfma_f32_16x16x32_bf16 v[212:215], v[176:179], v[192:195], 0
    s_waitcnt lgkmcnt(2)
    v_mfma_f32_16x16x32_bf16 v[208:211], v[164:167], v[196:199], v[208:211]
    v_mfma_f32_16x16x32_bf16 v[212:215], v[180:183], v[196:199], v[212:215]
    s_waitcnt lgkmcnt(1)
    v_mfma_f32_16x16x32_bf16 v[208:211], v[168:171], v[200:203], v[208:211]
    v_mfma_f32_16x16x32_bf16 v[212:215], v[184:187], v[200:203], v[212:215]
    s_waitcnt lgkmcnt(0)
    v_mfma_f32_16x16x32_bf16 v[208:211], v[172:175], v[204:207], v[208:211]
    v_mfma_f32_16x16x32_bf16 v[212:215], v[188:191], v[204:207], v[212:215]
    s_nop 7
    v_cvt_pk_bf16_f32 v216, v208, v209
    v_cvt_pk_bf16_f32 v217, v210, v211
    v_cvt_pk_bf16_f32 v218, v212, v213
    v_cvt_pk_bf16_f32 v219, v214, v215
    s_mov_b32 exec_lo, 0xff00ff
    s_mov_b32 exec_hi, 0xff00ff
    buffer_store_dwordx4 v[216:219], v253, s[8:11], s63 offen sc1
    s_mov_b64 exec, -1
L_nof2:
    s_waitcnt vmcnt(0)
    s_barrier
    s_add_u32 s58, s58, 0x300000
    s_add_u32 s59, s59, 0x300000
    s_add_u32 s60, s60, 0x300000
    s_add_u32 s61, s61, 0x300000
    s_add_u32 s62, s62, 0x300000
    s_add_u32 s63, s63, 0x300000
    s_mov_b32 s76, 0x00FF00FF
    s_add_u32 s51, s51, 1
    s_cmp_lt_u32 s51, 2
    s_cbranch_scc1 L_wloop
    s_branch L_fin
L_rt_f2:
    s_sub_u32 s52, s52, 1
    s_cmp_lt_i32 s52, 0
    s_cbranch_scc1 L_pd_f2
    s_mov_b32 s53, s66
    v_max3_u32 v190, v0, v1, v2
    v_max_u32 v190, v190, v3
    v_cmp_eq_u32 vcc, -1, v190
    s_mov_b64 exec, vcc
    s_cbranch_execz L_sl1
    buffer_load_dwordx4 v[0:3], v140, s[8:11], s53 offen offset:0 sc1
L_sl1:
    s_mov_b64 exec, -1
    v_max3_u32 v190, v4, v5, v6
    v_max_u32 v190, v190, v7
    v_cmp_eq_u32 vcc, -1, v190
    s_mov_b64 exec, vcc
    s_cbranch_execz L_sl2
    buffer_load_dwordx4 v[4:7], v140, s[8:11], s53 offen offset:256 sc1
L_sl2:
    s_mov_b64 exec, -1
    s_add_u32 s53, s53, 8192
    v_max3_u32 v190, v8, v9, v10
    v_max_u32 v190, v190, v11
    v_cmp_eq_u32 vcc, -1, v190
    s_mov_b64 exec, vcc
    s_cbranch_execz L_sl3
    buffer_load_dwordx4 v[8:11], v140, s[8:11], s53 offen offset:0 sc1
L_sl3:
    s_mov_b64 exec, -1
    v_max3_u32 v190, v12, v13, v14
    v_max_u32 v190, v190, v15
    v_cmp_eq_u32 vcc, -1, v190
    s_mov_b64 exec, vcc
    s_cbranch_execz L_sl4
    buffer_load_dwordx4 v[12:15], v140, s[8:11], s53 offen offset:256 sc1
L_sl4:
    s_mov_b64 exec, -1
    s_add_u32 s53, s53, 8192
    v_max3_u32 v190, v16, v17, v18
    v_max_u32 v190, v190, v19
    v_cmp_eq_u32 vcc, -1, v190
    s_mov_b64 exec, vcc
    s_cbranch_execz L_sl5
    buffer_load_dwordx4 v[16:19], v140, s[8:11], s53 offen offset:0 sc1
L_sl5:
    s_mov_b64 exec, -1
    v_max3_u32 v190, v20, v21, v22
    v_max_u32 v190, v190, v23
    v_cmp_eq_u32 vcc, -1, v190
    s_mov_b64 exec, vcc
    s_cbranch_execz L_sl6
    buffer_load_dwordx4 v[20:23], v140, s[8:11], s53 offen offset:256 sc1
L_sl6:
    s_mov_b64 exec, -1
    s_add_u32 s53, s53, 8192
    v_max3_u32 v190, v24, v25, v26
    v_max_u32 v190, v190, v27
    v_cmp_eq_u32 vcc, -1, v190
    s_mov_b64 exec, vcc
    s_cbranch_execz L_sl7
    buffer_load_dwordx4 v[24:27], v140, s[8:11], s53 offen offset:0 sc1
L_sl7:
    s_mov_b64 exec, -1
    v_max3_u32 v190, v28, v29, v30
    v_max_u32 v190, v190, v31
    v_cmp_eq_u32 vcc, -1, v190
    s_mov_b64 exec, vcc
    s_cbranch_execz L_sl8
    buffer_load_dwordx4 v[28:31], v140, s[8:11], s53 offen offset:256 sc1
L_sl8:
    s_mov_b64 exec, -1
    s_add_u32 s53, s53, 8192
    v_max3_u32 v190, v32, v33, v34
    v_max_u32 v190, v190, v35
    v_cmp_eq_u32 vcc, -1, v190
    s_mov_b64 exec, vcc
    s_cbranch_execz L_sl9
    buffer_load_dwordx4 v[32:35], v140, s[8:11], s53 offen offset:0 sc1
L_sl9:
    s_mov_b64 exec, -1
    v_max3_u32 v190, v36, v37, v38
    v_max_u32 v190, v190, v39
    v_cmp_eq_u32 vcc, -1, v190
    s_mov_b64 exec, vcc
    s_cbranch_execz L_sl10
    buffer_load_dwordx4 v[36:39], v140, s[8:11], s53 offen offset:256 sc1
L_sl10:
    s_mov_b64 exec, -1
    s_add_u32 s53, s53, 8192
    v_max3_u32 v190, v40, v41, v42
    v_max_u32 v190, v190, v43
    v_cmp_eq_u32 vcc, -1, v190
    s_mov_b64 exec, vcc
    s_cbranch_execz L_sl11
    buffer_load_dwordx4 v[40:43], v140, s[8:11], s53 offen offset:0 sc1
L_sl11:
    s_mov_b64 exec, -1
    v_max3_u32 v190, v44, v45, v46
    v_max_u32 v190, v190, v47
    v_cmp_eq_u32 vcc, -1, v190
    s_mov_b64 exec, vcc
    s_cbranch_execz L_sl12
    buffer_load_dwordx4 v[44:47], v140, s[8:11], s53 offen offset:256 sc1
L_sl12:
    s_mov_b64 exec, -1
    s_add_u32 s53, s53, 8192
    v_max3_u32 v190, v48, v49, v50
    v_max_u32 v190, v190, v51
    v_cmp_eq_u32 vcc, -1, v190
    s_mov_b64 exec, vcc
    s_cbranch_execz L_sl13
    buffer_load_dwordx4 v[48:51], v140, s[8:11], s53 offen offset:0 sc1
L_sl13:
    s_mov_b64 exec, -1
    v_max3_u32 v190, v52, v53, v54
    v_max_u32 v190, v190, v55
    v_cmp_eq_u32 vcc, -1, v190
    s_mov_b64 exec, vcc
    s_cbranch_execz L_sl14
    buffer_load_dwordx4 v[52:55], v140, s[8:11], s53 offen offset:256 sc1
L_sl14:
    s_mov_b64 exec, -1
    s_waitcnt vmcnt(0)
    s_branch L_pm_f2
L_rt_q:
    s_sub_u32 s52, s52, 1
    s_cmp_lt_i32 s52, 0
    s_cbranch_scc1 L_pd_q
    s_cmp_lg_u32 s51, 0
    s_cbranch_scc1 L_skip_cq0True
    v_max3_u32 v190, v16, v17, v18
    v_max_u32 v190, v190, v19
    v_cmp_eq_u32 vcc, -1, v190
    s_mov_b64 exec, vcc
    s_cbranch_execz L_sl15
    buffer_load_dwordx4 v[16:19], v143, s[8:11], s69 offen offset:0 sc1
L_sl15:
    s_mov_b64 exec, -1
    v_max3_u32 v190, v20, v21, v22
    v_max_u32 v190, v190, v23
    v_cmp_eq_u32 vcc, -1, v190
    s_mov_b64 exec, vcc
    s_cbranch_execz L_sl16
    buffer_load_dwordx4 v[20:23], v143, s[8:11], s69 offen offset:256 sc1
L_sl16:
    s_mov_b64 exec, -1
    v_max3_u32 v190, v24, v25, v26
    v_max_u32 v190, v190, v27
    v_cmp_eq_u32 vcc, -1, v190
    s_mov_b64 exec, vcc
    s_cbranch_execz L_sl17
    buffer_load_dwordx4 v[24:27], v143, s[8:11], s69 offen offset:2048 sc1
L_sl17:
    s_mov_b64 exec, -1
    v_max3_u32 v190, v28, v29, v30
    v_max_u32 v190, v190, v31
    v_cmp_eq_u32 vcc, -1, v190
    s_mov_b64 exec, vcc
    s_cbranch_execz L_sl18
    buffer_load_dwordx4 v[28:31], v143, s[8:11], s69 offen offset:2304 sc1
L_sl18:
    s_mov_b64 exec, -1
L_skip_cq0True:
    buffer_load_dwordx2 v[108:109], v142, s[8:11], s70 offen sc1
    v_max3_u32 v190, v0, v1, v2
    v_max_u32 v190, v190, v3
    v_cmp_eq_u32 vcc, -1, v190
    s_mov_b64 exec, vcc
    s_cbranch_execz L_sl19
    buffer_load_dwordx4 v[0:3], v151, s[8:11], s68 offen offset:0 sc1
L_sl19:
    s_mov_b64 exec, -1
    v_max3_u32 v190, v4, v5, v6
    v_max_u32 v190, v190, v7
    v_cmp_eq_u32 vcc, -1, v190
    s_mov_b64 exec, vcc
    s_cbranch_execz L_sl20
    buffer_load_dwordx4 v[4:7], v151, s[8:11], s68 offen offset:2048 sc1
L_sl20:
    s_mov_b64 exec, -1
    v_max3_u32 v190, v8, v9, v10
    v_max_u32 v190, v190, v11
    v_cmp_eq_u32 vcc, -1, v190
    s_mov_b64 exec, vcc
    s_cbranch_execz L_sl21
    buffer_load_dwordx4 v[8:11], v152, s[8:11], s68 offen offset:0 sc1
L_sl21:
    s_mov_b64 exec, -1
    v_max3_u32 v190, v12, v13, v14
    v_max_u32 v190, v190, v15
    v_cmp_eq_u32 vcc, -1, v190
    s_mov_b64 exec, vcc
    s_cbranch_execz L_sl22
    buffer_load_dwordx4 v[12:15], v152, s[8:11], s68 offen offset:2048 sc1
L_sl22:
    s_mov_b64 exec, -1
    s_waitcnt vmcnt(0)
    s_branch L_pm_q
L_rt_a:
    s_sub_u32 s52, s52, 1
    s_cmp_lt_i32 s52, 0
    s_cbranch_scc1 L_pd_a
    s_cmp_lg_u32 s51, 0
    s_cbranch_scc1 L_skip_c3True
    s_mov_b32 s53, 0x2c0000
    buffer_load_dword v189, v188, s[8:11], s53 offen sc1
L_skip_c3True:
    buffer_load_dwordx2 v[108:109], v144, s[8:11], s72 offen offset:0 sc1
    buffer_load_dwordx2 v[110:111], v144, s[8:11], s72 offen offset:128 sc1
    v_max3_u32 v190, v0, v1, v2
    v_max_u32 v190, v190, v3
    v_cmp_eq_u32 vcc, -1, v190
    s_mov_b64 exec, vcc
    s_cbranch_execz L_sl23
    buffer_load_dwordx4 v[0:3], v151, s[8:11], s71 offen offset:0 sc1
L_sl23:
    s_mov_b64 exec, -1
    v_max3_u32 v190, v4, v5, v6
    v_max_u32 v190, v190, v7
    v_cmp_eq_u32 vcc, -1, v190
    s_mov_b64 exec, vcc
    s_cbranch_execz L_sl24
    buffer_load_dwordx4 v[4:7], v151, s[8:11], s71 offen offset:2048 sc1
L_sl24:
    s_mov_b64 exec, -1
    v_max3_u32 v190, v8, v9, v10
    v_max_u32 v190, v190, v11
    v_cmp_eq_u32 vcc, -1, v190
    s_mov_b64 exec, vcc
    s_cbranch_execz L_sl25
    buffer_load_dwordx4 v[8:11], v152, s[8:11], s71 offen offset:0 sc1
L_sl25:
    s_mov_b64 exec, -1
    v_max3_u32 v190, v12, v13, v14
    v_max_u32 v190, v190, v15
    v_cmp_eq_u32 vcc, -1, v190
    s_mov_b64 exec, vcc
    s_cbranch_execz L_sl26
    buffer_load_dwordx4 v[12:15], v152, s[8:11], s71 offen offset:2048 sc1
L_sl26:
    s_mov_b64 exec, -1
    s_waitcnt vmcnt(0)
    s_branch L_pm_a
L_rt_o:
    s_sub_u32 s52, s52, 1
    s_cmp_lt_i32 s52, 0
    s_cbranch_scc1 L_pd_o
    s_mov_b32 s53, s67
    v_max3_u32 v190, v0, v1, v2
    v_max_u32 v190, v190, v3
    v_cmp_eq_u32 vcc, -1, v190
    s_mov_b64 exec, vcc
    s_cbranch_execz L_sl27
    buffer_load_dwordx4 v[0:3], v140, s[8:11], s53 offen offset:0 sc1
L_sl27:
    s_mov_b64 exec, -1
    v_max3_u32 v190, v4, v5, v6
    v_max_u32 v190, v190, v7
    v_cmp_eq_u32 vcc, -1, v190
    s_mov_b64 exec, vcc
    s_cbranch_execz L_sl28
    buffer_load_dwordx4 v[4:7], v140, s[8:11], s53 offen offset:256 sc1
L_sl28:
    s_mov_b64 exec, -1
    s_add_u32 s53, s53, 8192
    v_max3_u32 v190, v8, v9, v10
    v_max_u32 v190, v190, v11
    v_cmp_eq_u32 vcc, -1, v190
    s_mov_b64 exec, vcc
    s_cbranch_execz L_sl29
    buffer_load_dwordx4 v[8:11], v140, s[8:11], s53 offen offset:0 sc1
L_sl29:
    s_mov_b64 exec, -1
    v_max3_u32 v190, v12, v13, v14
    v_max_u32 v190, v190, v15
    v_cmp_eq_u32 vcc, -1, v190
    s_mov_b64 exec, vcc
    s_cbranch_execz L_sl30
    buffer_load_dwordx4 v[12:15], v140, s[8:11], s53 offen offset:256 sc1
L_sl30:
    s_mov_b64 exec, -1
    s_add_u32 s53, s53, 8192
    v_max3_u32 v190, v16, v17, v18
    v_max_u32 v190, v190, v19
    v_cmp_eq_u32 vcc, -1, v190
    s_mov_b64 exec, vcc
    s_cbranch_execz L_sl31
    buffer_load_dwordx4 v[16:19], v140, s[8:11], s53 offen offset:0 sc1
L_sl31:
    s_mov_b64 exec, -1
    v_max3_u32 v190, v20, v21, v22
    v_max_u32 v190, v190, v23
    v_cmp_eq_u32 vcc, -1, v190
    s_mov_b64 exec, vcc
    s_cbranch_execz L_sl32
    buffer_load_dwordx4 v[20:23], v140, s[8:11], s53 offen offset:256 sc1
L_sl32:
    s_mov_b64 exec, -1
    s_add_u32 s53, s53, 8192
    v_max3_u32 v190, v24, v25, v26
    v_max_u32 v190, v190, v27
    v_cmp_eq_u32 vcc, -1, v190
    s_mov_b64 exec, vcc
    s_cbranch_execz L_sl33
    buffer_load_dwordx4 v[24:27], v140, s[8:11], s53 offen offset:0 sc1
L_sl33:
    s_mov_b64 exec, -1
    v_max3_u32 v190, v28, v29, v30
    v_max_u32 v190, v190, v31
    v_cmp_eq_u32 vcc, -1, v190
    s_mov_b64 exec, vcc
    s_cbranch_execz L_sl34
    buffer_load_dwordx4 v[28:31], v140, s[8:11], s53 offen offset:256 sc1
L_sl34:
    s_mov_b64 exec, -1
    s_add_u32 s53, s53, 8192
    v_max3_u32 v190, v32, v33, v34
    v_max_u32 v190, v190, v35
    v_cmp_eq_u32 vcc, -1, v190
    s_mov_b64 exec, vcc
    s_cbranch_execz L_sl35
    buffer_load_dwordx4 v[32:35], v140, s[8:11], s53 offen offset:0 sc1
L_sl35:
    s_mov_b64 exec, -1
    v_max3_u32 v190, v36, v37, v38
    v_max_u32 v190, v190, v39
    v_cmp_eq_u32 vcc, -1, v190
    s_mov_b64 exec, vcc
    s_cbranch_execz L_sl36
    buffer_load_dwordx4 v[36:39], v140, s[8:11], s53 offen offset:256 sc1
L_sl36:
    s_mov_b64 exec, -1
    s_add_u32 s53, s53, 8192
    v_max3_u32 v190, v40, v41, v42
    v_max_u32 v190, v190, v43
    v_cmp_eq_u32 vcc, -1, v190
    s_mov_b64 exec, vcc
    s_cbranch_execz L_sl37
    buffer_load_dwordx4 v[40:43], v140, s[8:11], s53 offen offset:0 sc1
L_sl37:
    s_mov_b64 exec, -1
    v_max3_u32 v190, v44, v45, v46
    v_max_u32 v190, v190, v47
    v_cmp_eq_u32 vcc, -1, v190
    s_mov_b64 exec, vcc
    s_cbranch_execz L_sl38
    buffer_load_dwordx4 v[44:47], v140, s[8:11], s53 offen offset:256 sc1
L_sl38:
    s_mov_b64 exec, -1
    s_add_u32 s53, s53, 8192
    v_max3_u32 v190, v48, v49, v50
    v_max_u32 v190, v190, v51
    v_cmp_eq_u32 vcc, -1, v190
    s_mov_b64 exec, vcc
    s_cbranch_execz L_sl39
    buffer_load_dwordx4 v[48:51], v140, s[8:11], s53 offen offset:0 sc1
L_sl39:
    s_mov_b64 exec, -1
    v_max3_u32 v190, v52, v53, v54
    v_max_u32 v190, v190, v55
    v_cmp_eq_u32 vcc, -1, v190
    s_mov_b64 exec, vcc
    s_cbranch_execz L_sl40
    buffer_load_dwordx4 v[52:55], v140, s[8:11], s53 offen offset:256 sc1
L_sl40:
    s_mov_b64 exec, -1
    s_add_u32 s53, s53, 8192
    v_max3_u32 v190, v56, v57, v58
    v_max_u32 v190, v190, v59
    v_cmp_eq_u32 vcc, -1, v190
    s_mov_b64 exec, vcc
    s_cbranch_execz L_sl41
    buffer_load_dwordx4 v[56:59], v140, s[8:11], s53 offen offset:0 sc1
L_sl41:
    s_mov_b64 exec, -1
    v_max3_u32 v190, v60, v61, v62
    v_max_u32 v190, v190, v63
    v_cmp_eq_u32 vcc, -1, v190
    s_mov_b64 exec, vcc
    s_cbranch_execz L_sl42
    buffer_load_dwordx4 v[60:63], v140, s[8:11], s53 offen offset:256 sc1
L_sl42:
    s_mov_b64 exec, -1
    s_waitcnt vmcnt(0)
    s_branch L_pm_o
L_rt_h:
    s_sub_u32 s52, s52, 1
    s_cmp_lt_i32 s52, 0
    s_cbranch_scc1 L_pd_h
    s_cmp_lg_u32 s51, 0
    s_cbranch_scc1 L_skip_cf0True
    v_max3_u32 v190, v16, v17, v18
    v_max_u32 v190, v190, v19
    v_cmp_eq_u32 vcc, -1, v190
    s_mov_b64 exec, vcc
    s_cbranch_execz L_sl43
    buffer_load_dwordx4 v[16:19], v141, s[8:11], s74 offen offset:0 sc1
L_sl43:
    s_mov_b64 exec, -1
    v_max3_u32 v190, v20, v21, v22
    v_max_u32 v190, v190, v23
    v_cmp_eq_u32 vcc, -1, v190
    s_mov_b64 exec, vcc
    s_cbranch_execz L_sl44
    buffer_load_dwordx4 v[20:23], v141, s[8:11], s74 offen offset:32 sc1
L_sl44:
    s_mov_b64 exec, -1
    v_max3_u32 v190, v24, v25, v26
    v_max_u32 v190, v190, v27
    v_cmp_eq_u32 vcc, -1, v190
    s_mov_b64 exec, vcc
    s_cbranch_execz L_sl45
    buffer_load_dwordx4 v[24:27], v141, s[8:11], s74 offen offset:1024 sc1
L_sl45:
    s_mov_b64 exec, -1
    v_max3_u32 v190, v28, v29, v30
    v_max_u32 v190, v190, v31
    v_cmp_eq_u32 vcc, -1, v190
    s_mov_b64 exec, vcc
    s_cbranch_execz L_sl46
    buffer_load_dwordx4 v[28:31], v141, s[8:11], s74 offen offset:1056 sc1
L_sl46:
    s_mov_b64 exec, -1
L_skip_cf0True:
    buffer_load_dwordx2 v[108:109], v149, s[8:11], s75 offen sc1
    s_add_u32 s53, s73, 8192
    v_max3_u32 v190, v0, v1, v2
    v_max_u32 v190, v190, v3
    v_cmp_eq_u32 vcc, -1, v190
    s_mov_b64 exec, vcc
    s_cbranch_execz L_sl47
    buffer_load_dwordx4 v[0:3], v140, s[8:11], s73 offen offset:0 sc1
L_sl47:
    s_mov_b64 exec, -1
    v_max3_u32 v190, v4, v5, v6
    v_max_u32 v190, v190, v7
    v_cmp_eq_u32 vcc, -1, v190
    s_mov_b64 exec, vcc
    s_cbranch_execz L_sl48
    buffer_load_dwordx4 v[4:7], v140, s[8:11], s73 offen offset:256 sc1
L_sl48:
    s_mov_b64 exec, -1
    v_max3_u32 v190, v8, v9, v10
    v_max_u32 v190, v190, v11
    v_cmp_eq_u32 vcc, -1, v190
    s_mov_b64 exec, vcc
    s_cbranch_execz L_sl49
    buffer_load_dwordx4 v[8:11], v140, s[8:11], s53 offen offset:0 sc1
L_sl49:
    s_mov_b64 exec, -1
    v_max3_u32 v190, v12, v13, v14
    v_max_u32 v190, v190, v15
    v_cmp_eq_u32 vcc, -1, v190
    s_mov_b64 exec, vcc
    s_cbranch_execz L_sl50
    buffer_load_dwordx4 v[12:15], v140, s[8:11], s53 offen offset:256 sc1
L_sl50:
    s_mov_b64 exec, -1
    s_waitcnt vmcnt(0)
    s_branch L_pm_h
L_codeend:
.section .rodata,"a"
.p2align 6
.amdhsa_kernel interleave_layers__sliding_block_cached__dense_activation_silu__decode_kernel
  .amdhsa_next_free_vgpr 256
  .amdhsa_next_free_sgpr 102
  .amdhsa_accum_offset 256
  .amdhsa_group_segment_fixed_size 0
  .amdhsa_kernarg_size 88
  .amdhsa_user_sgpr_count 2
  .amdhsa_user_sgpr_kernarg_segment_ptr 1
  .amdhsa_system_sgpr_workgroup_id_x 1
.end_amdhsa_kernel
```
